```python
import torch

def _softmax(x, axis=-1):
    return torch.softmax(x, dim=axis)
def _gelu(x):
    return torch.nn.functional.gelu(x, approximate="tanh")
def _silu(x):
    return torch.nn.functional.silu(x)
def _sigmoid(x):
    return torch.sigmoid(x)
def _layernorm(x, axis=-1, eps=1e-5):
    m = x.mean(dim=axis, keepdim=True)
    v = x.var(dim=axis, keepdim=True, unbiased=False)
    return (x - m) / torch.sqrt(v + eps)
def _scatter_add(tgt, idx, src, axis=0):
    return tgt.clone().index_add_(axis, idx, src)
def _segment_sum(src, seg, n):
    out = torch.zeros((n,) + src.shape[1:], dtype=src.dtype)
    return out.index_add_(0, seg, src)
def _pad(x, pw):
    flat = tuple(v for pair in reversed(pw) for v in pair)
    return torch.nn.functional.pad(x, flat)

kernel_name = 'concat_heads__ssm_conv_s4d__ssm_conv_s4d__prompt'

def setup_inputs():

    _w = (lambda a: (lambda t: t.to(torch.bfloat16) if t.is_floating_point() else t)(torch.as_tensor(a)))
    def _A_setup():
        Bsz, L, D, N = 1, 2048, 576, 128
        return {
            "u": _w((lambda *s: torch.randn(*s, dtype=torch.bfloat16) * 0.05)(Bsz, L, D)),
            "log_A_real": _w((lambda *s: torch.randn(*s, dtype=torch.bfloat16) * 6.4)(D, N) * 0.5),
            "A_imag": _w((lambda *s: torch.randn(*s, dtype=torch.bfloat16) * 0.05)(D, N) * 3.14),
            "C_real": _w((lambda *s: torch.randn(*s, dtype=torch.bfloat16) * 0.05)(D, N) / N ** 0.5),
            "C_imag": _w((lambda *s: torch.randn(*s, dtype=torch.bfloat16) * 0.05)(D, N) / N ** 0.5),
            "log_dt": _w((lambda *s: torch.randn(*s, dtype=torch.bfloat16) * 0.05)(D) * 0.5 - 4.0),
            "D_skip": _w((lambda *s: torch.randn(*s, dtype=torch.bfloat16) * 0.05)(D)),
        }
    _A_in = _A_setup()

    def _B_setup():
        Bsz, L, D, N = 1, 2048, 576, 128
        return {
            "u": _w((lambda *s: torch.randn(*s, dtype=torch.bfloat16) * 0.05)(Bsz, L, D)),
            "log_A_real": _w((lambda *s: torch.randn(*s, dtype=torch.bfloat16) * 6.4)(D, N) * 0.5),
            "A_imag": _w((lambda *s: torch.randn(*s, dtype=torch.bfloat16) * 0.05)(D, N) * 3.14),
            "C_real": _w((lambda *s: torch.randn(*s, dtype=torch.bfloat16) * 0.05)(D, N) / N ** 0.5),
            "C_imag": _w((lambda *s: torch.randn(*s, dtype=torch.bfloat16) * 0.05)(D, N) / N ** 0.5),
            "log_dt": _w((lambda *s: torch.randn(*s, dtype=torch.bfloat16) * 0.05)(D) * 0.5 - 4.0),
            "D_skip": _w((lambda *s: torch.randn(*s, dtype=torch.bfloat16) * 0.05)(D)),
        }
    _B_in = _B_setup()

    return {
        "A_u": _A_in["u"],
        "A_log_A_real": _A_in["log_A_real"],
        "A_A_imag": _A_in["A_imag"],
        "A_C_real": _A_in["C_real"],
        "A_C_imag": _A_in["C_imag"],
        "A_log_dt": _A_in["log_dt"],
        "A_D_skip": _A_in["D_skip"],
        "B_u": _B_in["u"],
        "B_log_A_real": _B_in["log_A_real"],
        "B_A_imag": _B_in["A_imag"],
        "B_C_real": _B_in["C_real"],
        "B_C_imag": _B_in["C_imag"],
        "B_log_dt": _B_in["log_dt"],
        "B_D_skip": _B_in["D_skip"],
    }

def reference(A_u, A_log_A_real, A_A_imag, A_C_real, A_C_imag, A_log_dt, A_D_skip, B_u, B_log_A_real, B_A_imag, B_C_real, B_C_imag, B_log_dt, B_D_skip):
    def _A_ref(u, log_A_real, A_imag, C_real, C_imag, log_dt, D_skip):
        L = u.shape[1]
        dt = torch.exp(log_dt)
        A = -torch.exp(log_A_real) + 1j * A_imag
        C = (C_real + 1j * C_imag) * dt[:, None]
        pos = (lambda x, dt: x.to(dt))(torch.arange(L), log_dt.dtype)
        P = torch.exp((A * dt[:, None])[:, :, None] * pos[None, None, :])
        K = 2.0 * torch.einsum("dn,dnl->dl", C, P).real
        L2 = 2 * L
        u_t = (lambda x, *d: x.permute(*d))(u, 0, 2, 1)
        Kf = (lambda x, *a, **k: torch.fft.rfft(x.float(), *a, **k))(K, L2)
        Uf = (lambda x, *a, **k: torch.fft.rfft(x.float(), *a, **k))(u_t, L2)
        y = (lambda x, *a, **k: torch.fft.irfft(x, *a, **k).to(torch.bfloat16))(Uf * Kf[None, :, :], L2)[:, :, :L]
        y = (lambda x, *d: x.permute(*d))(y, 0, 2, 1)
        return y + u * D_skip[None, None, :]

    def _B_ref(u, log_A_real, A_imag, C_real, C_imag, log_dt, D_skip):
        L = u.shape[1]
        dt = torch.exp(log_dt)
        A = -torch.exp(log_A_real) + 1j * A_imag
        C = (C_real + 1j * C_imag) * dt[:, None]
        pos = (lambda x, dt: x.to(dt))(torch.arange(L), log_dt.dtype)
        P = torch.exp((A * dt[:, None])[:, :, None] * pos[None, None, :])
        K = 2.0 * torch.einsum("dn,dnl->dl", C, P).real
        L2 = 2 * L
        u_t = (lambda x, *d: x.permute(*d))(u, 0, 2, 1)
        Kf = (lambda x, *a, **k: torch.fft.rfft(x.float(), *a, **k))(K, L2)
        Uf = (lambda x, *a, **k: torch.fft.rfft(x.float(), *a, **k))(u_t, L2)
        y = (lambda x, *a, **k: torch.fft.irfft(x, *a, **k).to(torch.bfloat16))(Uf * Kf[None, :, :], L2)[:, :, :L]
        y = (lambda x, *d: x.permute(*d))(y, 0, 2, 1)
        return y + u * D_skip[None, None, :]

    a = _A_ref(A_u, A_log_A_real, A_A_imag, A_C_real, A_C_imag, A_log_dt, A_D_skip)
    b = _B_ref(B_u, B_log_A_real, B_A_imag, B_C_real, B_C_imag, B_log_dt, B_D_skip)
    return torch.concatenate([a, b], axis=-1)
```

```asm
; @launch grid=(216,1,1) block=(512,1,1) lds=160528
.amdgcn_target "amdgcn-amd-amdhsa--gfx950"
.text
.globl concat_heads__ssm_conv_s4d__ssm_conv_s4d__prompt_kernel
.p2align 8
.type concat_heads__ssm_conv_s4d__ssm_conv_s4d__prompt_kernel,@function
concat_heads__ssm_conv_s4d__ssm_conv_s4d__prompt_kernel:
    s_and_b32 s7, s2, 4
    s_mul_i32 s7, s7, 14
    s_load_dwordx16 s[8:23], s[0:1], s7
    s_getpc_b64 s[56:57]
    v_lshlrev_b32 v10, 7, v0
    v_mov_b32 v11, s57
    v_add_co_u32 v10, vcc, s56, v10
    v_readfirstlane_b32 s4, v0
    s_lshr_b32 s6, s2, 3
    v_addc_co_u32 v11, vcc, 0, v11, vcc
    s_lshr_b32 s4, s4, 6
    s_cmp_lt_u32 s4, 2
    s_cbranch_scc0 L_cpf
    global_load_dword v12, v[10:11], off
L_cpf:
    s_cmp_ge_u32 s2, 216
    s_cbranch_scc1 L_end
    s_mul_i32 s7, s6, 11
    s_lshr_b32 s7, s7, 5
    s_mul_i32 s28, s6, 3
    s_sub_u32 s28, s28, s7
    s_lshl_b32 s26, s6, 1
    s_add_u32 s26, s26, 18
    s_min_u32 s28, s28, s26
    s_and_b32 s5, s2, 3
    s_mul_i32 s26, s5, 72
    s_add_u32 s26, s26, s28
    s_lshl_b32 s26, s26, 1
    s_lshr_b32 s52, s4, 1
    s_add_u32 s52, s52, 2
    s_min_u32 s52, s52, s4
    s_add_u32 s27, s52, s26
    s_min_u32 s27, s27, 575
    v_and_b32 v204, 63, v0
    s_lshl_b32 s28, s27, 8
    v_lshl_add_u32 v156, v204, 2, s28
    s_lshl_b32 s28, s27, 1
    v_mov_b32 v157, s28
    s_waitcnt lgkmcnt(0)
    global_load_dword v72, v156, s[10:11]
    global_load_ushort v76, v157, s[18:19]
    global_load_dword v73, v156, s[12:13]
    global_load_dword v74, v156, s[14:15]
    global_load_dword v75, v156, s[16:17]
    global_load_ushort v77, v157, s[20:21]
    s_load_dwordx2 s[24:25], s[0:1], 112
    v_mov_b32 v7, 0
    v_mov_b32 v4, 0
    v_mov_b32 v232, 0
    v_mov_b32 v179, 0
    s_mul_i32 s7, s7, 3
    s_sub_u32 s7, s6, s7
    s_lshr_b32 s38, s7, 1
    s_cmp_ge_u32 s6, 27
    s_cselect_b32 s38, 1, s38
    s_and_b32 s33, s2, 4
    s_mul_i32 s33, s33, 144
    s_add_u32 s39, s26, s33
    s_and_b32 s47, s4, 3
    s_lshr_b32 s59, s47, 1
    s_and_b32 s43, s4, 1
    s_add_u32 s43, s43, 1
    s_cmp_lt_u32 s4, 4
    s_cselect_b32 s43, 0, s43
    s_cselect_b32 s49, 0, s38
    v_and_b32 v205, 15, v204
    v_lshrrev_b32 v206, 4, v204
    s_mul_i32 s29, s4, 15232
    s_mov_b32 s40, 0x05040100
    s_mov_b32 s41, 0x07060302
    s_cmp_lt_u32 s4, 4
    s_cbranch_scc1 L_nold
    s_cmp_eq_u32 s4, 7
    s_cbranch_scc0 L_nopf
    v_min_u32 v158, 56, v204
    v_mul_u32_u24 v5, 21846, v158
    v_lshrrev_b32 v5, 16, v5
    v_mul_u32_u24 v156, 3, v5
    v_sub_u32 v158, v158, v156
    s_mul_i32 s28, s6, 19
    s_min_u32 s28, s28, 493
    v_add_u32 v5, s28, v5
    v_mul_u32_u24 v5, 1152, v5
    v_lshl_add_u32 v5, v158, 7, v5
    s_lshl_b32 s28, s5, 8
    v_add_u32 v232, s28, v5
    global_load_dword v188, v232, s[8:9]
    v_add_u32 v232, 589824, v232
    global_load_dword v189, v232, s[8:9]
    v_add_u32 v232, 589824, v232
L_nopf:
    v_and_b32 v158, 255, v0
    v_mul_u32_u24 v7, 4608, v158
    s_lshl_b32 s28, s26, 1
    v_add_u32 v7, s28, v7
    s_lshl_b32 s33, s47, 9
    s_add_u32 s33, s33, 122368
    v_lshl_add_u32 v253, v204, 3, s33
L_nold:
    v_and_b32 v207, 31, v204
    v_lshrrev_b32 v231, 5, v204
    s_mov_b32 m0, s29
    s_mul_i32 s32, s52, 4608
    s_add_u32 s32, s32, 121856
    s_mov_b32 s34, 0x131a1215
    s_mov_b32 s35, 0x1b1d1f14
    s_mov_b32 s36, 0x9030305
    s_mov_b32 s37, 0x2030107
    s_lshl_b32 s33, s4, 3
    s_lshr_b64 s[34:35], s[34:35], s33
    s_lshr_b64 s[36:37], s[36:37], s33
    s_bfm_b32 s34, s36, s34
    s_mov_b32 s35, 0
    s_cmp_ge_u32 s4, 5
    s_mov_b32 s36, 0x3f80
    s_cselect_b32 s36, 0xffff, s36
    v_lshlrev_b32 v156, 3, v206
    v_sub_u32 v156, v156, v205
    v_add_u32 v156, 15, v156
    v_lshrrev_b64 v[112:113], v156, s[34:35]
    s_mov_b32 s37, 0x10001
    v_bfe_u32 v157, v112, 0, 2
    v_lshl_or_b32 v157, v157, 15, v157
    v_and_b32 v157, s37, v157
    v_mul_u32_u24 v104, s36, v157
    v_bfe_u32 v157, v112, 2, 2
    v_lshl_or_b32 v157, v157, 15, v157
    v_and_b32 v157, s37, v157
    v_mul_u32_u24 v105, s36, v157
    v_bfe_u32 v157, v112, 4, 2
    v_lshl_or_b32 v157, v157, 15, v157
    v_and_b32 v157, s37, v157
    v_mul_u32_u24 v106, s36, v157
    v_bfe_u32 v157, v112, 6, 2
    v_lshl_or_b32 v157, v157, 15, v157
    v_and_b32 v157, s37, v157
    v_mul_u32_u24 v107, s36, v157
    s_lshl_b32 s33, s4, 10
    s_add_u32 s33, s33, 149504
    v_lshlrev_b32 v5, 4, v204
    v_add_u32 v156, s33, v5
    ds_write_b128 v156, v[104:107]
    v_mov_b64 v[168:169], 0
    v_mov_b64 v[170:171], 0
    v_lshl_add_u32 v157, v207, 4, s32
    ds_write_b128 v157, v[168:171]
    v_min_u32 v157, 11, v204
    v_lshlrev_b32 v157, 8, v157
    v_add_u32 v157, 157696, v157
    ds_write_b128 v157, v[168:171]
    v_mov_b32 v0, 1
    v_lshlrev_b32 v208, 2, v204
    v_add_u32 v208, 157696, v208
    v_mul_u32_u24 v156, 272, v207
    v_lshl_add_u32 v156, v231, 4, v156
    v_add_u32 v252, s29, v156
    s_cmp_ge_u32 s4, 6
    s_cselect_b32 s48, 1, 0
    s_mov_b32 s42, 0
    s_mov_b32 s53, 0x40000
    s_mov_b32 s55, 0x7fff7fff
    s_cmp_eq_u32 s43, 2
    s_cselect_b32 s54, 16, 0
    v_cmp_eq_u32 vcc, 0, v204
    s_waitcnt lgkmcnt(0)
    s_barrier
    v_add_u32 v112, 149504, v5
    ds_read_b128 v[120:123], v112 offset:0
    ds_read_b128 v[124:127], v112 offset:1024
    ds_read_b128 v[128:131], v112 offset:2048
    ds_read_b128 v[132:135], v112 offset:3072
    ds_read_b128 v[136:139], v112 offset:4096
    ds_read_b128 v[240:243], v112 offset:5120
    ds_read_b128 v[244:247], v112 offset:6144
    ds_read_b128 v[248:251], v112 offset:7168
    s_cmp_lt_u32 s4, 4
    s_cbranch_scc0 L_pwa
    s_waitcnt vmcnt(0)
    s_setprio 0
    s_branch L_pw
L_pwa:
    s_cmp_eq_u32 s4, 4
    s_cbranch_scc0 L_n4_e
    s_cmp_eq_u32 s49, 1
    s_cbranch_scc1 L_n4_2
    global_load_dwordx3 v[172:174], v7, s[8:9] offset:0
    global_load_dwordx3 v[176:178], v7, s[8:9] offset:1152
    global_load_dwordx3 v[180:182], v7, s[8:9] offset:2304
    global_load_dwordx3 v[184:186], v7, s[8:9] offset:3456
    s_branch L_n4_e
L_n4_2:
    global_load_dwordx2 v[172:173], v7, s[8:9] offset:0
    global_load_dwordx2 v[176:177], v7, s[8:9] offset:1152
    global_load_dwordx2 v[180:181], v7, s[8:9] offset:2304
    global_load_dwordx2 v[184:185], v7, s[8:9] offset:3456
L_n4_e:
    v_lshlrev_b32 v156, 4, v205
    v_lshl_add_u32 v156, v206, 2, v156
    v_mul_u32_u24 v156, 2304, v156
    s_and_b32 s56, s4, 1
    s_lshl_b32 s58, s56, 1
    s_add_u32 s58, s58, s59
    s_mul_i32 s58, s58, 2304
    s_lshl_b32 s33, s39, 1
    s_add_u32 s50, s33, 3456
    v_add_u32 v179, s50, v156
    s_add_u32 s33, s33, s58
    s_add_u32 s33, s33, 4128768
    v_add_u32 v4, s33, v156
    s_cmp_eq_u32 s59, 0
    s_cselect_b32 s58, s40, s41
    s_lshl_b32 s56, s56, 8
    s_add_u32 s56, s56, 7936
    v_lshl_add_u32 v3, v204, 2, s56
    s_cmp_eq_u32 s49, 1
    s_cbranch_scc1 L_io0
    v_lshl_add_u32 v2, v204, 2, s29
    v_mov_b32 v210, 159744
    v_lshlrev_b32 v156, 5, v205
    v_lshl_add_u32 v156, v206, 4, v156
    v_add_u32 v1, s32, v156
    v_lshlrev_b32 v156, 4, v207
    v_lshl_add_u32 v156, v231, 3, v156
    s_add_u32 s33, s29, 504
    v_sub_u32 v228, s33, v156
    v_add_u32 v229, 1216, v228
    v_add_u32 v230, 2432, v228
    v_and_b32 v156, 7, v204
    v_min_u32 v157, 6, v156
    v_lshlrev_b32 v158, 4, v157
    v_cmp_lt_u32 vcc, 3, v157
    v_add_u32 v157, 1008, v158
    v_bfe_u32 v159, v204, 3, 2
    v_cndmask_b32 v158, v158, v157, vcc
    v_mul_u32_u24 v157, 1216, v159
    v_add3_u32 v235, v157, v158, s29
    v_min_u32 v156, 3, v156
    v_lshlrev_b32 v156, 4, v156
    v_mul_u32_u24 v159, 448, v159
    v_add_u32 v156, 1536, v156
    v_add_u32 v156, v156, v159
    v_lshlrev_b32 v157, 4, v205
    v_cmp_lt_u32 vcc, 7, v205
    v_add_u32 v158, 240, v157
    v_mul_u32_u24 v159, 640, v206
    v_cndmask_b32 v157, v157, v158, vcc
    v_cmp_lt_u32 vcc, 31, v204
    v_add_u32 v157, v159, v157
    s_add_u32 s33, s29, 4864
    v_cndmask_b32 v157, v157, v156, vcc
    v_add_u32 v236, s33, v157
    v_and_b32 v158, 3, v205
    v_lshrrev_b32 v159, 2, v205
    v_mul_u32_u24 v156, 448, v158
    v_sub_u32 v157, v206, v159
    v_lshlrev_b32 v157, 4, v157
    v_sub_u32 v156, v157, v156
    s_add_u32 s33, s29, 7552
    v_add_u32 v239, s33, v156
    v_mul_u32_u24 v156, 1216, v158
    v_lshl_add_u32 v157, v159, 3, v157
    v_sub_u32 v156, v157, v156
    s_cmp_eq_u32 s43, 2
    s_cselect_b32 s33, -15232, 0
    s_add_u32 s33, s29, s33
    s_add_u32 s33, s33, 3672
    v_add_u32 v237, s33, v156
    v_and_b32 v156, 1, v205
    v_mul_u32_u24 v156, 640, v156
    v_lshrrev_b32 v157, 1, v205
    v_lshl_add_u32 v156, v157, 4, v156
    v_lshlrev_b32 v157, 5, v206
    v_sub_u32 v156, v157, v156
    s_add_u32 s33, s29, 5616
    v_add_u32 v238, s33, v156
    v_lshlrev_b32 v157, 7, v231
    v_lshl_add_u32 v156, v207, 2, v157
    s_add_u32 s33, s29, 5236
    v_sub_u32 v233, s33, v156
    v_lshl_add_u32 v156, v207, 1, v157
    s_add_u32 s33, s29, 6338
    v_sub_u32 v234, s33, v156
    s_add_u32 s33, s29, 12800
    v_lshl_add_u32 v163, v204, 4, s33
    s_cmp_eq_u32 s43, 2
    s_movk_i32 s33, 15232
    s_cselect_b32 s33, -15232, s33
    v_add_u32 v164, s33, v163
    s_lshl_b32 s33, s47, 2
    s_add_u32 s33, s33, 159744
    v_mov_b32 v209, s33
    v_add_u32 v211, 60928, v3
    v_cmp_eq_u32 vcc, 0, v204
    s_waitcnt vmcnt(4)
    s_cmp_eq_u32 s4, 4
    s_cbranch_scc1 L_pw0
    s_waitcnt vmcnt(2)
    s_cmp_eq_u32 s4, 7
    s_cbranch_scc1 L_pw0
    s_waitcnt vmcnt(0)
L_pw0:
    s_setprio 1
    s_cmp_eq_u32 s4, 5
    s_cbranch_scc0 L_pw
    global_load_dwordx3 v[172:174], v7, s[8:9] offset:0
    global_load_dwordx3 v[176:178], v7, s[8:9] offset:1152
    global_load_dwordx3 v[180:182], v7, s[8:9] offset:2304
    global_load_dwordx3 v[184:186], v7, s[8:9] offset:3456
L_pw:
    v_lshlrev_b32 v77, 16, v77
    v_and_b32 v114, s55, v74
    v_and_b32 v115, s55, v75
    v_lshlrev_b32 v76, 16, v76
    v_pk_max_u16 v114, v114, v115
    v_mul_f32 v76, 0x3fb8aa3b, v76
    v_max_u16_sdwa v114, v114, v114 dst_sel:DWORD dst_unused:UNUSED_PAD src0_sel:WORD_0 src1_sel:WORD_1
    v_exp_f32 v76, v76
    v_lshrrev_b32 v72, s54, v72
    v_max_u32_dpp v114, v114, v114 row_shr:1 row_mask:0xf bank_mask:0xf
    v_cvt_pk_bf16_f32 v76, v76, v76
    v_lshrrev_b32 v73, s54, v73
    v_max_u32_dpp v114, v114, v114 row_shr:2 row_mask:0xf bank_mask:0xf
    v_and_b32 v76, 0xffff0000, v76
    v_lshrrev_b32 v74, s54, v74
    v_max_u32_dpp v114, v114, v114 row_shr:4 row_mask:0xf bank_mask:0xf
    v_mul_f32 v78, 0xbfb8aa3b, v76
    v_lshrrev_b32 v75, s54, v75
    v_max_u32_dpp v114, v114, v114 row_shr:8 row_mask:0xf bank_mask:0xf
    v_mul_f32 v79, 0.15915494, v76
    v_add_f32 v76, v76, v76
    v_max_u32_dpp v114, v114, v114 row_bcast:15 row_mask:0xa bank_mask:0xf
    v_cndmask_b32 v254, 0, v77, vcc
    v_cndmask_b32 v165, 0, 1, vcc
    v_max_u32_dpp v114, v114, v114 row_bcast:31 row_mask:0xc bank_mask:0xf
    s_nop 0
    v_readlane_b32 s56, v114, 63
    s_lshr_b32 s56, s56, 7
    s_max_u32 s56, s56, 1
    s_min_u32 s56, s56, 253
    s_sub_u32 s57, 254, s56
    s_lshl_b32 s56, s56, 23
    s_lshl_b32 s57, s57, 23
    v_mul_f32 v255, s56, v76
L_kg:
    v_lshlrev_b32 v112, 16, v72
    v_mul_f32 v112, 0x3fb8aa3b, v112
    v_exp_f32 v112, v112
    v_lshlrev_b32 v113, 16, v73
    v_cvt_pk_bf16_f32 v112, v112, v112
    v_mul_f32 v113, v113, v79
    v_and_b32 v112, 0xffff0000, v112
    v_fract_f32 v113, v113
    v_mul_f32 v112, v112, v78
    v_exp_f32 v96, v112
    v_cos_f32 v82, v113
    v_sin_f32 v83, v113
    v_lshlrev_b32 v102, 16, v74
    v_lshlrev_b32 v103, 16, v75
    v_pk_mul_f32 v[82:83], v[82:83], v[96:97] op_sel_hi:[1,0]
    v_mul_f32 v102, s57, v102
    v_mul_f32 v103, s57, v103
    v_pk_mul_f32 v[94:95], v[82:83], v[82:83] op_sel_hi:[0,1]
    v_cvt_pk_f16_f32 v98, v82, v83
    v_cvt_pk_f16_f32 v117, v102, v103
    v_pk_fma_f32 v[82:83], v[82:83], v[82:83], v[94:95] op_sel:[1,1,0] op_sel_hi:[1,0,1] neg_lo:[1,0,0]
    v_pk_mul_f32 v[94:95], v[82:83], v[82:83] op_sel_hi:[0,1]
    v_cvt_pk_f16_f32 v99, v82, v83
    v_mov_b32 v217, 0x3c00
    v_pk_fma_f32 v[82:83], v[82:83], v[82:83], v[94:95] op_sel:[1,1,0] op_sel_hi:[1,0,1] neg_lo:[1,0,0]
    v_pk_mul_f32 v[94:95], v[82:83], v[82:83] op_sel_hi:[0,1]
    v_cvt_pk_f16_f32 v100, v82, v83
    v_pk_fma_f32 v[82:83], v[82:83], v[82:83], v[94:95] op_sel:[1,1,0] op_sel_hi:[1,0,1] neg_lo:[1,0,0]
    v_pk_mul_f32 v[94:95], v[82:83], v[82:83] op_sel_hi:[0,1]
    v_cvt_pk_f16_f32 v101, v82, v83
    v_cvt_pk_f16_f32 v212, v82, -v83
    v_pk_fma_f32 v[82:83], v[82:83], v[82:83], v[94:95] op_sel:[1,1,0] op_sel_hi:[1,0,1] neg_lo:[1,0,0]
    v_pk_mul_f32 v[94:95], v[82:83], v[82:83] op_sel_hi:[0,1]
    v_cvt_pk_f16_f32 v213, v82, -v83
    v_pk_fma_f32 v[82:83], v[82:83], v[82:83], v[94:95] op_sel:[1,1,0] op_sel_hi:[1,0,1] neg_lo:[1,0,0]
    v_pk_mul_f32 v[94:95], v[82:83], v[82:83] op_sel_hi:[0,1]
    v_cvt_pk_f16_f32 v214, v82, -v83
    v_pk_fma_f32 v[82:83], v[82:83], v[82:83], v[94:95] op_sel:[1,1,0] op_sel_hi:[1,0,1] neg_lo:[1,0,0]
    v_pk_mul_f32 v[94:95], v[82:83], v[82:83] op_sel_hi:[0,1]
    v_cvt_pk_f16_f32 v215, v82, -v83
    v_pk_fma_f32 v[82:83], v[82:83], v[82:83], v[94:95] op_sel:[1,1,0] op_sel_hi:[1,0,1] neg_lo:[1,0,0]
    v_pk_mul_f32 v[94:95], v[82:83], v[82:83] op_sel_hi:[0,1]
    v_cvt_pk_f16_f32 v216, v82, -v83
    v_pk_fma_f32 v[82:83], v[82:83], v[82:83], v[94:95] op_sel:[1,1,0] op_sel_hi:[1,0,1] neg_lo:[1,0,0]
    v_pk_mul_f32 v[94:95], v[82:83], v[82:83] op_sel_hi:[0,1]
    v_cvt_pk_f16_f32 v114, v82, v83
    v_pk_fma_f32 v[82:83], v[82:83], v[82:83], v[94:95] op_sel:[1,1,0] op_sel_hi:[1,0,1] neg_lo:[1,0,0]
    v_pk_mul_f32 v[94:95], v[82:83], v[82:83] op_sel_hi:[0,1]
    v_cvt_pk_f16_f32 v115, v82, v83
    v_pk_fma_f32 v[82:83], v[82:83], v[82:83], v[94:95] op_sel:[1,1,0] op_sel_hi:[1,0,1] neg_lo:[1,0,0]
    v_cvt_pk_f16_f32 v116, v82, v83
    s_cmp_eq_u32 s42, 0
    s_cbranch_scc1 L_kg2
    s_waitcnt lgkmcnt(12)
    v_mfma_f32_32x32x16_f16 v[140:155], v[8:11], v[12:15], 0
    v_lshl_add_u32 v2, v204, 2, s29
    v_mov_b32 v210, 159744
    v_lshlrev_b32 v156, 5, v205
    v_lshl_add_u32 v156, v206, 4, v156
    v_add_u32 v1, s32, v156
    v_lshlrev_b32 v156, 4, v207
    v_lshl_add_u32 v156, v231, 3, v156
    s_add_u32 s33, s29, 504
    v_sub_u32 v228, s33, v156
    v_mfma_f32_32x32x16_f16 v[140:155], v[16:19], v[20:23], v[140:155]
    v_add_u32 v229, 1216, v228
    v_add_u32 v230, 2432, v228
    v_and_b32 v156, 7, v204
    v_min_u32 v157, 6, v156
    v_lshlrev_b32 v158, 4, v157
    v_cmp_lt_u32 vcc, 3, v157
    v_add_u32 v157, 1008, v158
    v_bfe_u32 v159, v204, 3, 2
    v_cndmask_b32 v158, v158, v157, vcc
    s_waitcnt lgkmcnt(8)
    v_mfma_f32_32x32x16_f16 v[140:155], v[24:27], v[28:31], v[140:155]
    v_mul_u32_u24 v157, 1216, v159
    v_add3_u32 v235, v157, v158, s29
    v_min_u32 v156, 3, v156
    v_lshlrev_b32 v156, 4, v156
    v_mul_u32_u24 v159, 448, v159
    v_add_u32 v156, 1536, v156
    v_add_u32 v156, v156, v159
    v_lshlrev_b32 v157, 4, v205
    v_cmp_lt_u32 vcc, 7, v205
    v_mfma_f32_32x32x16_f16 v[140:155], v[32:35], v[36:39], v[140:155]
    v_add_u32 v158, 240, v157
    v_mul_u32_u24 v159, 640, v206
    v_cndmask_b32 v157, v157, v158, vcc
    v_cmp_lt_u32 vcc, 31, v204
    v_add_u32 v157, v159, v157
    s_add_u32 s33, s29, 4864
    v_cndmask_b32 v157, v157, v156, vcc
    v_add_u32 v236, s33, v157
    v_and_b32 v158, 3, v205
    s_waitcnt lgkmcnt(4)
    v_mfma_f32_32x32x16_f16 v[140:155], v[40:43], v[44:47], v[140:155]
    v_lshrrev_b32 v159, 2, v205
    v_mul_u32_u24 v156, 448, v158
    v_sub_u32 v157, v206, v159
    v_lshlrev_b32 v157, 4, v157
    v_sub_u32 v156, v157, v156
    s_add_u32 s33, s29, 7552
    v_add_u32 v239, s33, v156
    v_mul_u32_u24 v156, 1216, v158
    v_lshl_add_u32 v157, v159, 3, v157
    v_mfma_f32_32x32x16_f16 v[140:155], v[48:51], v[52:55], v[140:155]
    v_sub_u32 v156, v157, v156
    s_cmp_eq_u32 s43, 2
    s_cselect_b32 s33, -15232, 0
    s_add_u32 s33, s29, s33
    s_add_u32 s33, s33, 3672
    v_add_u32 v237, s33, v156
    v_and_b32 v156, 1, v205
    v_mul_u32_u24 v156, 640, v156
    v_lshrrev_b32 v157, 1, v205
    s_waitcnt lgkmcnt(0)
    v_mfma_f32_32x32x16_f16 v[140:155], v[56:59], v[60:63], v[140:155]
    v_lshl_add_u32 v156, v157, 4, v156
    v_lshlrev_b32 v157, 5, v206
    v_sub_u32 v156, v157, v156
    s_add_u32 s33, s29, 5616
    v_add_u32 v238, s33, v156
    v_lshlrev_b32 v157, 7, v231
    v_lshl_add_u32 v156, v207, 2, v157
    s_add_u32 s33, s29, 5236
    v_sub_u32 v233, s33, v156
    v_mfma_f32_32x32x16_f16 v[140:155], v[64:67], v[68:71], v[140:155]
    v_lshl_add_u32 v156, v207, 1, v157
    s_add_u32 s33, s29, 6338
    v_sub_u32 v234, s33, v156
L_kg2:
    s_cmp_eq_u32 s48, 1
    s_cbranch_scc1 L_n67x
L_n67:
    ds_write_addtid_b32 v217 offset:6528
    ds_write_addtid_b32 v212 offset:6800
    ds_write_addtid_b32 v213 offset:7072
    ds_write_addtid_b32 v214 offset:7616
    ds_write_addtid_b32 v215 offset:8704
    ds_write_addtid_b32 v216 offset:10880
    v_pk_mul_f16 v94, v213, v212 op_sel_hi:[0,1]
    v_pk_mul_f16 v95, v214, v212 op_sel_hi:[0,1]
    v_pk_fma_f16 v104, v213, v212, v94 op_sel:[1,1,0] op_sel_hi:[1,0,1] neg_lo:[1,0,0]
    v_pk_fma_f16 v105, v214, v212, v95 op_sel:[1,1,0] op_sel_hi:[1,0,1] neg_lo:[1,0,0]
    ds_write_addtid_b32 v104 offset:7344
    ds_write_addtid_b32 v105 offset:7888
    v_pk_mul_f16 v94, v214, v213 op_sel_hi:[0,1]
    v_pk_mul_f16 v95, v215, v212 op_sel_hi:[0,1]
    v_pk_fma_f16 v106, v214, v213, v94 op_sel:[1,1,0] op_sel_hi:[1,0,1] neg_lo:[1,0,0]
    v_pk_fma_f16 v107, v215, v212, v95 op_sel:[1,1,0] op_sel_hi:[1,0,1] neg_lo:[1,0,0]
    ds_write_addtid_b32 v106 offset:8160
    ds_write_addtid_b32 v107 offset:8976
    v_pk_mul_f16 v94, v106, v212 op_sel_hi:[0,1]
    v_pk_mul_f16 v95, v215, v213 op_sel_hi:[0,1]
    v_pk_fma_f16 v108, v106, v212, v94 op_sel:[1,1,0] op_sel_hi:[1,0,1] neg_lo:[1,0,0]
    v_pk_fma_f16 v109, v215, v213, v95 op_sel:[1,1,0] op_sel_hi:[1,0,1] neg_lo:[1,0,0]
    ds_write_addtid_b32 v108 offset:8432
    ds_write_addtid_b32 v109 offset:9248
    v_pk_mul_f16 v94, v109, v212 op_sel_hi:[0,1]
    v_pk_mul_f16 v95, v215, v214 op_sel_hi:[0,1]
    v_pk_fma_f16 v110, v109, v212, v94 op_sel:[1,1,0] op_sel_hi:[1,0,1] neg_lo:[1,0,0]
    v_pk_fma_f16 v111, v215, v214, v95 op_sel:[1,1,0] op_sel_hi:[1,0,1] neg_lo:[1,0,0]
    ds_write_addtid_b32 v110 offset:9520
    ds_write_addtid_b32 v111 offset:9792
    v_pk_mul_f16 v94, v111, v212 op_sel_hi:[0,1]
    v_pk_mul_f16 v95, v111, v213 op_sel_hi:[0,1]
    v_pk_fma_f16 v220, v111, v212, v94 op_sel:[1,1,0] op_sel_hi:[1,0,1] neg_lo:[1,0,0]
    v_pk_fma_f16 v221, v111, v213, v95 op_sel:[1,1,0] op_sel_hi:[1,0,1] neg_lo:[1,0,0]
    ds_write_addtid_b32 v220 offset:10064
    ds_write_addtid_b32 v221 offset:10336
    v_pk_mul_f16 v94, v221, v212 op_sel_hi:[0,1]
    v_pk_mul_f16 v95, v216, v212 op_sel_hi:[0,1]
    v_pk_fma_f16 v222, v221, v212, v94 op_sel:[1,1,0] op_sel_hi:[1,0,1] neg_lo:[1,0,0]
    v_pk_fma_f16 v223, v216, v212, v95 op_sel:[1,1,0] op_sel_hi:[1,0,1] neg_lo:[1,0,0]
    ds_write_addtid_b32 v222 offset:10608
    ds_write_addtid_b32 v223 offset:11152
    v_pk_mul_f16 v94, v216, v213 op_sel_hi:[0,1]
    v_pk_mul_f16 v95, v216, v214 op_sel_hi:[0,1]
    v_pk_fma_f16 v224, v216, v213, v94 op_sel:[1,1,0] op_sel_hi:[1,0,1] neg_lo:[1,0,0]
    v_pk_fma_f16 v225, v216, v214, v95 op_sel:[1,1,0] op_sel_hi:[1,0,1] neg_lo:[1,0,0]
    ds_write_addtid_b32 v224 offset:11424
    ds_write_addtid_b32 v225 offset:11968
    v_pk_mul_f16 v94, v224, v212 op_sel_hi:[0,1]
    v_pk_mul_f16 v95, v225, v212 op_sel_hi:[0,1]
    v_pk_fma_f16 v226, v224, v212, v94 op_sel:[1,1,0] op_sel_hi:[1,0,1] neg_lo:[1,0,0]
    v_pk_fma_f16 v227, v225, v212, v95 op_sel:[1,1,0] op_sel_hi:[1,0,1] neg_lo:[1,0,0]
    ds_write_addtid_b32 v226 offset:11696
    ds_write_addtid_b32 v227 offset:12240
    v_pk_mul_f16 v94, v225, v213 op_sel_hi:[0,1]
    v_pk_mul_f16 v95, v216, v215 op_sel_hi:[0,1]
    v_pk_fma_f16 v104, v225, v213, v94 op_sel:[1,1,0] op_sel_hi:[1,0,1] neg_lo:[1,0,0]
    v_pk_fma_f16 v105, v216, v215, v95 op_sel:[1,1,0] op_sel_hi:[1,0,1] neg_lo:[1,0,0]
    ds_write_addtid_b32 v104 offset:12512
    ds_write_addtid_b32 v105 offset:13056
    v_pk_mul_f16 v94, v104, v212 op_sel_hi:[0,1]
    v_pk_mul_f16 v95, v105, v212 op_sel_hi:[0,1]
    v_pk_fma_f16 v107, v104, v212, v94 op_sel:[1,1,0] op_sel_hi:[1,0,1] neg_lo:[1,0,0]
    v_pk_fma_f16 v106, v105, v212, v95 op_sel:[1,1,0] op_sel_hi:[1,0,1] neg_lo:[1,0,0]
    ds_write_addtid_b32 v107 offset:12784
    ds_write_addtid_b32 v106 offset:13328
    v_pk_mul_f16 v94, v105, v213 op_sel_hi:[0,1]
    v_pk_mul_f16 v95, v105, v214 op_sel_hi:[0,1]
    v_pk_fma_f16 v108, v105, v213, v94 op_sel:[1,1,0] op_sel_hi:[1,0,1] neg_lo:[1,0,0]
    v_pk_fma_f16 v109, v105, v214, v95 op_sel:[1,1,0] op_sel_hi:[1,0,1] neg_lo:[1,0,0]
    ds_write_addtid_b32 v108 offset:13600
    ds_write_addtid_b32 v109 offset:14144
    v_pk_mul_f16 v94, v108, v212 op_sel_hi:[0,1]
    v_pk_mul_f16 v95, v109, v212 op_sel_hi:[0,1]
    v_pk_fma_f16 v110, v108, v212, v94 op_sel:[1,1,0] op_sel_hi:[1,0,1] neg_lo:[1,0,0]
    v_pk_fma_f16 v220, v109, v212, v95 op_sel:[1,1,0] op_sel_hi:[1,0,1] neg_lo:[1,0,0]
    ds_write_addtid_b32 v110 offset:13872
    ds_write_addtid_b32 v220 offset:14416
    v_pk_mul_f16 v94, v109, v213 op_sel_hi:[0,1]
    v_pk_fma_f16 v111, v109, v213, v94 op_sel:[1,1,0] op_sel_hi:[1,0,1] neg_lo:[1,0,0]
    ds_write_addtid_b32 v111 offset:14688
    v_pk_mul_f16 v94, v111, v212 op_sel_hi:[0,1]
    v_pk_fma_f16 v221, v111, v212, v94 op_sel:[1,1,0] op_sel_hi:[1,0,1] neg_lo:[1,0,0]
    ds_write_addtid_b32 v221 offset:14960
    s_cmp_eq_u32 s4, 4
    s_cbranch_scc1 L_T1
L_sF:
    ds_write_addtid_b32 v117 offset:0
    v_pk_mul_f16 v94, v117, v98 op_sel_hi:[0,1]
    v_pk_mul_f16 v95, v117, v99 op_sel_hi:[0,1]
    v_pk_fma_f16 v104, v117, v98, v94 op_sel:[1,1,0] op_sel_hi:[1,0,1] neg_lo:[1,0,0]
    v_pk_fma_f16 v105, v117, v99, v95 op_sel:[1,1,0] op_sel_hi:[1,0,1] neg_lo:[1,0,0]
    ds_write_addtid_b32 v104 offset:272
    ds_write_addtid_b32 v105 offset:544
    v_pk_mul_f16 v94, v117, v100 op_sel_hi:[0,1]
    v_pk_mul_f16 v95, v117, v101 op_sel_hi:[0,1]
    v_pk_fma_f16 v106, v117, v100, v94 op_sel:[1,1,0] op_sel_hi:[1,0,1] neg_lo:[1,0,0]
    v_pk_fma_f16 v107, v117, v101, v95 op_sel:[1,1,0] op_sel_hi:[1,0,1] neg_lo:[1,0,0]
    ds_write_addtid_b32 v106 offset:2176
    ds_write_addtid_b32 v106 offset:1088
    ds_write_addtid_b32 v107 offset:3264
    v_pk_mul_f16 v94, v117, v114 op_sel_hi:[0,1]
    v_pk_mul_f16 v95, v105, v98 op_sel_hi:[0,1]
    v_pk_fma_f16 v108, v117, v114, v94 op_sel:[1,1,0] op_sel_hi:[1,0,1] neg_lo:[1,0,0]
    v_pk_fma_f16 v109, v105, v98, v95 op_sel:[1,1,0] op_sel_hi:[1,0,1] neg_lo:[1,0,0]
    ds_write_addtid_b32 v108 offset:2448
    ds_write_addtid_b32 v109 offset:816
    v_pk_mul_f16 v94, v106, v98 op_sel_hi:[0,1]
    v_pk_mul_f16 v95, v106, v99 op_sel_hi:[0,1]
    v_pk_fma_f16 v110, v106, v98, v94 op_sel:[1,1,0] op_sel_hi:[1,0,1] neg_lo:[1,0,0]
    v_pk_fma_f16 v111, v106, v99, v95 op_sel:[1,1,0] op_sel_hi:[1,0,1] neg_lo:[1,0,0]
    ds_write_addtid_b32 v110 offset:1360
    ds_write_addtid_b32 v111 offset:1632
    v_pk_mul_f16 v94, v111, v98 op_sel_hi:[0,1]
    v_pk_mul_f16 v95, v108, v99 op_sel_hi:[0,1]
    v_pk_fma_f16 v220, v111, v98, v94 op_sel:[1,1,0] op_sel_hi:[1,0,1] neg_lo:[1,0,0]
    v_pk_fma_f16 v221, v108, v99, v95 op_sel:[1,1,0] op_sel_hi:[1,0,1] neg_lo:[1,0,0]
    ds_write_addtid_b32 v220 offset:1904
    ds_write_addtid_b32 v221 offset:2720
    v_pk_mul_f16 v94, v108, v100 op_sel_hi:[0,1]
    v_pk_mul_f16 v95, v108, v101 op_sel_hi:[0,1]
    v_pk_fma_f16 v222, v108, v100, v94 op_sel:[1,1,0] op_sel_hi:[1,0,1] neg_lo:[1,0,0]
    v_pk_fma_f16 v223, v108, v101, v95 op_sel:[1,1,0] op_sel_hi:[1,0,1] neg_lo:[1,0,0]
    ds_write_addtid_b32 v222 offset:2992
    ds_write_addtid_b32 v222 offset:3536
    ds_write_addtid_b32 v223 offset:4080
    v_pk_mul_f16 v94, v222, v99 op_sel_hi:[0,1]
    v_pk_mul_f16 v95, v106, v115 op_sel_hi:[0,1]
    v_pk_fma_f16 v224, v222, v99, v94 op_sel:[1,1,0] op_sel_hi:[1,0,1] neg_lo:[1,0,0]
    v_pk_fma_f16 v225, v106, v115, v95 op_sel:[1,1,0] op_sel_hi:[1,0,1] neg_lo:[1,0,0]
    ds_write_addtid_b32 v224 offset:3808
    ds_write_addtid_b32 v225 offset:4352
    v_pk_mul_f16 v94, v107, v115 op_sel_hi:[0,1]
    v_pk_mul_f16 v95, v222, v115 op_sel_hi:[0,1]
    v_pk_fma_f16 v226, v107, v115, v94 op_sel:[1,1,0] op_sel_hi:[1,0,1] neg_lo:[1,0,0]
    v_pk_fma_f16 v227, v222, v115, v95 op_sel:[1,1,0] op_sel_hi:[1,0,1] neg_lo:[1,0,0]
    ds_write_addtid_b32 v226 offset:4624
    ds_write_addtid_b32 v227 offset:5440
    v_pk_mul_f16 v94, v223, v115 op_sel_hi:[0,1]
    v_pk_mul_f16 v95, v107, v116 op_sel_hi:[0,1]
    v_pk_fma_f16 v104, v223, v115, v94 op_sel:[1,1,0] op_sel_hi:[1,0,1] neg_lo:[1,0,0]
    v_pk_fma_f16 v105, v107, v116, v95 op_sel:[1,1,0] op_sel_hi:[1,0,1] neg_lo:[1,0,0]
    ds_write_addtid_b32 v104 offset:5712
    ds_write_addtid_b32 v105 offset:4896
    v_pk_mul_f16 v94, v223, v116 op_sel_hi:[0,1]
    v_pk_mul_f16 v95, v226, v116 op_sel_hi:[0,1]
    v_pk_fma_f16 v109, v223, v116, v94 op_sel:[1,1,0] op_sel_hi:[1,0,1] neg_lo:[1,0,0]
    v_pk_fma_f16 v110, v226, v116, v95 op_sel:[1,1,0] op_sel_hi:[1,0,1] neg_lo:[1,0,0]
    ds_write_addtid_b32 v109 offset:5168
    ds_write_addtid_b32 v110 offset:5984
    v_pk_mul_f16 v94, v104, v116 op_sel_hi:[0,1]
    v_pk_fma_f16 v111, v104, v116, v94 op_sel:[1,1,0] op_sel_hi:[1,0,1] neg_lo:[1,0,0]
    ds_write_addtid_b32 v111 offset:6256
    ds_read_b128 v[8:11], v252 offset:0
    ds_read_b128 v[12:15], v252 offset:6528
    ds_read_b128 v[16:19], v252 offset:32
    ds_read_b128 v[20:23], v252 offset:6560
    ds_read_b128 v[24:27], v252 offset:64
    ds_read_b128 v[28:31], v252 offset:6592
    ds_read_b128 v[32:35], v252 offset:96
    ds_read_b128 v[36:39], v252 offset:6624
    ds_read_b128 v[40:43], v252 offset:128
    ds_read_b128 v[44:47], v252 offset:6656
    ds_read_b128 v[48:51], v252 offset:160
    ds_read_b128 v[52:55], v252 offset:6688
    ds_read_b128 v[56:59], v252 offset:192
    ds_read_b128 v[60:63], v252 offset:6720
    ds_read_b128 v[64:67], v252 offset:224
    ds_read_b128 v[68:71], v252 offset:6752
    s_cmp_lt_u32 s4, 4
    s_cbranch_scc0 L_auxX
    s_cmp_eq_u32 s42, 1
    s_cbranch_scc1 L_mainX
    s_mov_b32 s42, 1
    s_setprio 2
    v_lshrrev_b32 v72, 16, v72
    v_lshrrev_b32 v73, 16, v73
    v_lshrrev_b32 v74, 16, v74
    v_lshrrev_b32 v75, 16, v75
    s_branch L_kg
L_n67x:
    s_mov_b32 s48, 0
    global_load_dwordx3 v[172:174], v7, s[8:9] offset:0
    global_load_dwordx3 v[176:178], v7, s[8:9] offset:1152
    global_load_dwordx3 v[180:182], v7, s[8:9] offset:2304
    global_load_dwordx3 v[184:186], v7, s[8:9] offset:3456
    s_cmp_eq_u32 s4, 7
    s_cbranch_scc0 L_n67
    global_load_dword v188, v232, s[8:9]
    v_add_u32 v232, 589824, v232
    global_load_dword v189, v232, s[8:9]
    s_branch L_n67
L_T1:
    s_waitcnt vmcnt(0)
    v_add_u32 v7, 1179648, v7
    global_load_dwordx3 v[188:190], v7, s[8:9] offset:0
    global_load_dwordx3 v[192:194], v7, s[8:9] offset:1152
    global_load_dwordx3 v[196:198], v7, s[8:9] offset:2304
    global_load_dwordx3 v[200:202], v7, s[8:9] offset:3456
    v_perm_b32 v8, v176, v172, s40
    v_perm_b32 v9, v184, v180, s40
    ds_write_b64 v253, v[8:9] offset:0
    v_perm_b32 v10, v176, v172, s41
    v_perm_b32 v11, v184, v180, s41
    ds_write_b64 v253, v[10:11] offset:4608
    v_perm_b32 v12, v177, v173, s40
    v_perm_b32 v13, v185, v181, s40
    ds_write_b64 v253, v[12:13] offset:9216
    v_perm_b32 v14, v177, v173, s41
    v_perm_b32 v15, v185, v181, s41
    ds_write_b64 v253, v[14:15] offset:13824
    v_perm_b32 v16, v178, v174, s40
    v_perm_b32 v17, v186, v182, s40
    ds_write_b64 v253, v[16:17] offset:18432
    v_perm_b32 v18, v178, v174, s41
    v_perm_b32 v19, v186, v182, s41
    ds_write_b64 v253, v[18:19] offset:23040
    ds_add_u32 v208, v165 offset:2048
    s_branch L_sF
L_auxX:
    s_setprio 1
    s_waitcnt lgkmcnt(12)
    v_mfma_f32_32x32x16_f16 v[140:155], v[8:11], v[12:15], 0
    v_mfma_f32_32x32x16_f16 v[140:155], v[16:19], v[20:23], v[140:155]
    s_waitcnt lgkmcnt(8)
    v_mfma_f32_32x32x16_f16 v[140:155], v[24:27], v[28:31], v[140:155]
    v_mfma_f32_32x32x16_f16 v[140:155], v[32:35], v[36:39], v[140:155]
    s_waitcnt lgkmcnt(4)
    v_mfma_f32_32x32x16_f16 v[140:155], v[40:43], v[44:47], v[140:155]
    v_mfma_f32_32x32x16_f16 v[140:155], v[48:51], v[52:55], v[140:155]
    s_waitcnt lgkmcnt(0)
    v_mfma_f32_32x32x16_f16 v[140:155], v[56:59], v[60:63], v[140:155]
    v_mfma_f32_32x32x16_f16 v[140:155], v[64:67], v[68:71], v[140:155]
    s_cmp_eq_u32 s43, 2
    s_nop 9
    s_cbranch_scc1 L_xf
    ds_write_b128 v163, v[144:147]
    ds_write_b128 v163, v[148:151] offset:1024
    ds_write_b32 v209, v0 offset:256
    ds_write_b128 v235, v[168:171]
    s_branch L_xg
L_xf:
    ds_write_b128 v163, v[140:143]
    ds_write_b128 v163, v[144:147] offset:1024
    ds_write_b32 v209, v0 offset:256
    ds_write_b128 v236, v[168:171]
L_xg:
    s_cmp_eq_u32 s4, 4
    s_cbranch_scc1 L_noT
    s_waitcnt vmcnt(2)
    s_cmp_eq_u32 s4, 7
    s_cbranch_scc1 L_w7
    s_waitcnt vmcnt(0)
L_w7:
    v_add_u32 v7, 1179648, v7
    global_load_dwordx3 v[188:190], v7, s[8:9] offset:0
    global_load_dwordx3 v[192:194], v7, s[8:9] offset:1152
    global_load_dwordx3 v[196:198], v7, s[8:9] offset:2304
    global_load_dwordx3 v[200:202], v7, s[8:9] offset:3456
    v_perm_b32 v8, v176, v172, s40
    v_perm_b32 v9, v184, v180, s40
    ds_write_b64 v253, v[8:9] offset:0
    v_perm_b32 v10, v176, v172, s41
    v_perm_b32 v11, v184, v180, s41
    ds_write_b64 v253, v[10:11] offset:4608
    v_perm_b32 v12, v177, v173, s40
    v_perm_b32 v13, v185, v181, s40
    ds_write_b64 v253, v[12:13] offset:9216
    v_perm_b32 v14, v177, v173, s41
    v_perm_b32 v15, v185, v181, s41
    ds_write_b64 v253, v[14:15] offset:13824
    v_perm_b32 v16, v178, v174, s40
    v_perm_b32 v17, v186, v182, s40
    ds_write_b64 v253, v[16:17] offset:18432
    v_perm_b32 v18, v178, v174, s41
    v_perm_b32 v19, v186, v182, s41
    ds_write_b64 v253, v[18:19] offset:23040
    ds_add_u32 v208, v165 offset:2048
L_noT:
    s_setprio 1
    v_xor_b32 v213, 4, v209
    ds_read_b32 v212, v213 offset:256
    s_waitcnt lgkmcnt(0)
    v_readfirstlane_b32 s33, v212
    s_cmp_lt_u32 s33, 1
    s_cbranch_scc1 L_poll
L_poll_e:
    ds_read_b128 v[8:11], v164
    ds_read_b128 v[12:15], v164 offset:1024
    v_cmp_eq_u32 vcc, 2, v204
    s_cmp_eq_u32 s43, 2
    s_waitcnt lgkmcnt(0)
    s_cbranch_scc1 L_xf2
    v_add_f32 v140, v140, v8
    v_add_f32 v141, v141, v9
    v_add_f32 v142, v142, v10
    v_add_f32 v143, v143, v11
    v_add_f32 v144, v144, v12
    v_add_f32 v145, v145, v13
    v_add_f32 v146, v146, v14
    v_add_f32 v147, v147, v15
    s_branch L_T0
L_xf2:
    v_add_f32 v147, v147, v11
    v_add_f32 v148, v148, v12
    v_add_f32 v149, v149, v13
    v_add_f32 v150, v150, v14
    v_add_f32 v151, v151, v15
    v_mul_f32 v147, v147, v255
    s_branch L_T23
L_poll:
    ds_read_b32 v212, v213 offset:256
    s_waitcnt lgkmcnt(0)
    v_readfirstlane_b32 s33, v212
    s_cmp_lt_u32 s33, 1
    s_cbranch_scc0 L_poll_e
    s_sub_u32 s53, s53, 1
    s_cbranch_scc0 L_poll
    s_endpgm
L_mainX:
    s_setprio 3
    ds_read_b32 v213, v210
    ds_write_b128 v235, v[168:171]
    s_waitcnt lgkmcnt(14)
    v_mfma_f32_32x32x16_f16 v[140:155], v[8:11], v[12:15], v[140:155]
    v_mfma_f32_32x32x16_f16 v[140:155], v[16:19], v[20:23], v[140:155]
    s_waitcnt lgkmcnt(10)
    v_mfma_f32_32x32x16_f16 v[140:155], v[24:27], v[28:31], v[140:155]
    v_mfma_f32_32x32x16_f16 v[140:155], v[32:35], v[36:39], v[140:155]
    s_waitcnt lgkmcnt(1)
    v_readfirstlane_b32 s33, v213
    s_cmp_lt_u32 s33, 4
    s_cbranch_scc1 L_pollm
L_pollm_e:
    v_mfma_f32_32x32x16_f16 v[140:155], v[40:43], v[44:47], v[140:155]
    ds_read_b128 v[172:175], v1 offset:480
    ds_read_b128 v[176:179], v1 offset:416
    v_mfma_f32_32x32x16_f16 v[140:155], v[48:51], v[52:55], v[140:155]
    ds_read_b128 v[180:183], v1 offset:352
    ds_read_b128 v[184:187], v1 offset:288
    v_mfma_f32_32x32x16_f16 v[140:155], v[56:59], v[60:63], v[140:155]
    ds_read_b128 v[188:191], v1 offset:224
    ds_read_b128 v[192:195], v1 offset:160
    v_mfma_f32_32x32x16_f16 v[140:155], v[64:67], v[68:71], v[140:155]
    ds_read_b128 v[196:199], v1 offset:96
    ds_read_b128 v[200:203], v1 offset:32
    v_cmp_eq_u32 vcc, 2, v204
    s_nop 8
L_T0:
    v_fma_f32 v140, v140, v255, v254
    v_mul_f32 v141, v141, v255
    v_mul_f32 v142, v142, v255
    v_mul_f32 v143, v143, v255
    v_mul_f32 v144, v144, v255
    v_cvt_pk_bf16_f32 v156, v143, v142
    v_cvt_pk_bf16_f32 v157, v141, v140
    ds_write_b64 v228, v[156:157] offset:576
    v_cvt_pk_bf16_f32 v158, v144, v143
    ds_write2_b32 v230, v156, v157 offset0:143 offset1:144
    v_cvt_pk_bf16_f32 v159, v142, v141
    v_cvt_pk_bf16_f32 v166, v140, v140
    ds_write2_b32 v229, v158, v159 offset0:143 offset1:144
    ds_write_b64 v228, v[158:159] offset:4216
    ds_read_b64 v[8:9], v237 offset:1024
    ds_read_b64 v[10:11], v237 offset:1032
    v_readlane_b32 s44, v166, 0
    ds_read_b64 v[12:13], v237 offset:960
    ds_read_b64 v[14:15], v237 offset:968
    v_mul_f32 v145, v145, v255
    ds_read_b64 v[16:17], v237 offset:896
    ds_read_b64 v[18:19], v237 offset:904
    v_mul_f32 v146, v146, v255
    ds_read_b64 v[20:21], v237 offset:832
    ds_read_b64 v[22:23], v237 offset:840
    v_mul_f32 v147, v147, v255
    ds_read_b64 v[24:25], v237 offset:768
    ds_read_b64 v[26:27], v237 offset:776
    v_cvt_pk_bf16_f32 v160, v147, v146
    ds_read_b64 v[28:29], v237 offset:704
    ds_read_b64 v[30:31], v237 offset:712
    v_cvt_pk_bf16_f32 v161, v145, v145
    ds_read_b64 v[32:33], v237 offset:640
    ds_read_b64 v[34:35], v237 offset:648
    v_cvt_pk_bf16_f32 v162, v147, v147
    ds_read_b64 v[36:37], v237 offset:576
    ds_read_b64 v[38:39], v237 offset:584
    v_cvt_pk_bf16_f32 v163, v146, v145
    s_cmp_eq_u32 s43, 1
    s_cbranch_scc1 L_near
L_T23:
    v_mul_f32 v148, v148, v255
    v_mul_f32 v149, v149, v255
    v_mul_f32 v150, v150, v255
    v_mul_f32 v151, v151, v255
    v_cvt_pk_bf16_f32 v164, v149, v148
    v_cvt_pk_bf16_f32 v167, v149, v149
    v_cvt_pk_bf16_f32 v166, v147, v147
    s_cmp_eq_u32 s43, 2
    s_cbranch_scc1 L_far
    v_cvt_pk_bf16_f32 v165, v150, v151
    v_cndmask_b32 v5, 0, 1, vcc
    v_readlane_b32 s45, v166, 63
    v_readlane_b32 s46, v167, 63
    s_waitcnt lgkmcnt(14)
    v_and_or_b32 v8, s44, v240, v8
    v_and_or_b32 v9, s44, v241, v9
    v_and_or_b32 v10, s44, v242, v10
    v_and_or_b32 v11, s44, v243, v11
    s_nop 1
    v_mfma_f32_16x16x32_bf16 v[140:143], v[8:11], v[172:175], 0
    s_waitcnt lgkmcnt(12)
    v_mfma_f32_16x16x32_bf16 v[140:143], v[12:15], v[176:179], v[140:143]
    v_and_b32 v76, s46, v248
    v_and_b32 v77, s46, v249
    v_and_b32 v78, s46, v250
    v_and_b32 v79, s46, v251
    s_waitcnt lgkmcnt(10)
    v_mfma_f32_16x16x32_bf16 v[140:143], v[16:19], v[180:183], v[140:143]
    ds_write_b64 v228, v[160:161] offset:64
    ds_write2_b32 v230, v160, v161 offset0:15 offset1:16
    s_waitcnt lgkmcnt(10)
    v_mfma_f32_16x16x32_bf16 v[140:143], v[20:23], v[184:187], v[140:143]
    v_mov_b32 v252, v233
    v_mov_b32 v253, v234
    s_waitcnt lgkmcnt(8)
    v_mfma_f32_16x16x32_bf16 v[140:143], v[24:27], v[188:191], v[140:143]
    v_mov_b32 v254, v238
    v_mov_b32 v255, v239
    s_waitcnt lgkmcnt(6)
    v_mfma_f32_16x16x32_bf16 v[140:143], v[28:31], v[192:195], v[140:143]
    ds_write2_b32 v229, v162, v163 offset0:15 offset1:16
    ds_write_b64 v228, v[162:163] offset:3704
    s_waitcnt lgkmcnt(6)
    v_mfma_f32_16x16x32_bf16 v[140:143], v[32:35], v[196:199], v[140:143]
    ds_read_b128 v[204:207], v1 offset:464
    ds_read_b64 v[40:41], v237 offset:512
    s_waitcnt lgkmcnt(6)
    v_mfma_f32_16x16x32_bf16 v[140:143], v[36:39], v[200:203], v[140:143]
    ds_read_b64 v[42:43], v237 offset:520
    ds_read_b64 v[72:73], v237 offset:0
    s_waitcnt lgkmcnt(3)
    v_mfma_f32_16x16x32_bf16 v[212:215], v[204:207], v[120:123], 0
    ds_read_b64 v[74:75], v237 offset:8
    ds_read_b64 v[44:45], v237 offset:448
    v_mfma_f32_16x16x32_bf16 v[216:219], v[172:175], v[124:127], 0
    ds_read_b64 v[46:47], v237 offset:456
    ds_read_b64 v[48:49], v237 offset:384
    v_mfma_f32_16x16x32_bf16 v[220:223], v[172:175], v[120:123], 0
    ds_read_b64 v[50:51], v237 offset:392
    ds_read_b64 v[52:53], v237 offset:320
    v_mfma_f32_16x16x32_bf16 v[224:227], v[172:175], v[128:131], 0
    v_cvt_pk_bf16_f32 v6, v140, v141
    ds_read_b64 v[54:55], v237 offset:328
    v_mfma_f32_16x16x32_bf16 v[156:159], v[76:79], v[172:175], 0
    ds_read_b64 v[56:57], v237 offset:256
    v_cvt_pk_bf16_f32 v7, v142, v143
    s_waitcnt lgkmcnt(9)
    v_mfma_f32_16x16x32_bf16 v[144:147], v[40:43], v[172:175], 0
    ds_read_b64 v[58:59], v237 offset:264
    ds_read_b64 v[60:61], v237 offset:192
    s_waitcnt lgkmcnt(9)
    v_and_or_b32 v72, s45, v244, v72
    v_and_or_b32 v73, s45, v245, v73
    v_and_or_b32 v74, s45, v246, v74
    v_and_or_b32 v75, s45, v247, v75
    s_nop 1
    v_mfma_f32_16x16x32_bf16 v[148:151], v[72:75], v[172:175], 0
    ds_write2st64_b32 v2, v6, v7 offset0:31 offset1:32
    ds_read_b64 v[62:63], v237 offset:200
    v_mfma_f32_16x16x32_bf16 v[240:243], v[204:207], v[132:135], 0
    ds_read_b64 v[64:65], v237 offset:128
    ds_add_u32 v208, v5 offset:0
    s_setprio 0
    v_mfma_f32_16x16x32_bf16 v[244:247], v[172:175], v[136:139], 0
    ds_read_b64 v[66:67], v237 offset:136
    ds_read_b64 v[68:69], v237 offset:64
    s_waitcnt lgkmcnt(12)
    v_mfma_f32_16x16x32_bf16 v[144:147], v[44:47], v[176:179], v[144:147]
    ds_read_b64 v[70:71], v237 offset:72
    ds_write_b128 v236, v[168:171]
    s_waitcnt lgkmcnt(12)
    v_mfma_f32_16x16x32_bf16 v[144:147], v[48:51], v[180:183], v[144:147]
    ds_read_b128 v[172:175], v1 offset:992
    ds_read_b128 v[176:179], v1 offset:928
    s_waitcnt lgkmcnt(13)
    v_mfma_f32_16x16x32_bf16 v[144:147], v[52:55], v[184:187], v[144:147]
    ds_read_b128 v[180:183], v1 offset:864
    ds_read_b128 v[184:187], v1 offset:800
    s_waitcnt lgkmcnt(13)
    v_mfma_f32_16x16x32_bf16 v[144:147], v[56:59], v[188:191], v[144:147]
    ds_read_b128 v[188:191], v1 offset:736
    ds_read_b128 v[204:207], v1 offset:976
    s_waitcnt lgkmcnt(12)
    v_mfma_f32_16x16x32_bf16 v[144:147], v[60:63], v[192:195], v[144:147]
    ds_read_b128 v[192:195], v1 offset:672
    s_waitcnt lgkmcnt(10)
    v_mfma_f32_16x16x32_bf16 v[144:147], v[64:67], v[196:199], v[144:147]
    ds_read_b128 v[196:199], v1 offset:608
    s_waitcnt lgkmcnt(9)
    v_mfma_f32_16x16x32_bf16 v[144:147], v[68:71], v[200:203], v[144:147]
    ds_read_b128 v[200:203], v1 offset:544
    s_waitcnt lgkmcnt(8)
    v_mfma_f32_16x16x32_bf16 v[144:147], v[8:11], v[172:175], v[144:147]
    v_cvt_pk_bf16_f32 v228, v212, v216
    s_waitcnt lgkmcnt(7)
    v_mfma_f32_16x16x32_bf16 v[144:147], v[12:15], v[176:179], v[144:147]
    v_cvt_pk_bf16_f32 v229, v220, v224
    s_waitcnt lgkmcnt(6)
    v_mfma_f32_16x16x32_bf16 v[144:147], v[16:19], v[180:183], v[144:147]
    v_cvt_pk_bf16_f32 v230, v213, v217
    s_waitcnt lgkmcnt(5)
    v_mfma_f32_16x16x32_bf16 v[144:147], v[20:23], v[184:187], v[144:147]
    v_cvt_pk_bf16_f32 v231, v221, v225
    s_waitcnt lgkmcnt(3)
    v_mfma_f32_16x16x32_bf16 v[144:147], v[24:27], v[188:191], v[144:147]
    v_cvt_pk_bf16_f32 v232, v214, v218
    s_waitcnt lgkmcnt(2)
    v_mfma_f32_16x16x32_bf16 v[144:147], v[28:31], v[192:195], v[144:147]
    v_cvt_pk_bf16_f32 v233, v222, v226
    s_waitcnt lgkmcnt(1)
    v_mfma_f32_16x16x32_bf16 v[144:147], v[32:35], v[196:199], v[144:147]
    v_cvt_pk_bf16_f32 v234, v215, v219
    s_waitcnt lgkmcnt(0)
    v_mfma_f32_16x16x32_bf16 v[144:147], v[36:39], v[200:203], v[144:147]
    v_cvt_pk_bf16_f32 v235, v223, v227
    v_mfma_f32_16x16x32_bf16 v[148:151], v[40:43], v[172:175], v[148:151]
    v_cvt_pk_bf16_f32 v236, v240, v244
    v_cvt_pk_bf16_f32 v237, v241, v245
    v_mfma_f32_16x16x32_bf16 v[152:155], v[72:75], v[172:175], 0
    v_cvt_pk_bf16_f32 v238, v242, v246
    v_cvt_pk_bf16_f32 v239, v243, v247
    v_mfma_f32_16x16x32_bf16 v[160:163], v[76:79], v[172:175], 0
    ds_write_b32 v252, v164 offset:8
    ds_write_b32 v252, v164 offset:640
    v_mfma_f32_16x16x32_bf16 v[212:215], v[204:207], v[120:123], 0
    ds_write_b16 v253, v165 offset:76
    ds_write_b16_d16_hi v253, v165 offset:12
    v_mfma_f32_16x16x32_bf16 v[216:219], v[172:175], v[124:127], 0
    v_cvt_pk_bf16_f32 v6, v144, v145
    v_cvt_pk_bf16_f32 v7, v146, v147
    v_mfma_f32_16x16x32_bf16 v[220:223], v[172:175], v[120:123], 0
    ds_write2st64_b32 v2, v6, v7 offset0:33 offset1:34
    ds_add_u32 v208, v5 offset:256
    v_mfma_f32_16x16x32_bf16 v[224:227], v[172:175], v[128:131], 0
    ds_write_b16 v253, v165 offset:520
    ds_write_b16_d16_hi v253, v165 offset:456
    v_mfma_f32_16x16x32_bf16 v[240:243], v[204:207], v[132:135], 0
    ds_write_b16 v253, v165 offset:964
    ds_write_b16_d16_hi v253, v165 offset:900
    v_mfma_f32_16x16x32_bf16 v[244:247], v[172:175], v[136:139], 0
    ds_write_b16 v253, v165 offset:1408
    ds_write_b16_d16_hi v253, v165 offset:1344
    v_mfma_f32_16x16x32_bf16 v[148:151], v[44:47], v[176:179], v[148:151]
    ds_read_b128 v[80:83], v254 offset:256
    ds_read_b128 v[88:91], v254 offset:128
    v_mfma_f32_16x16x32_bf16 v[148:151], v[48:51], v[180:183], v[148:151]
    ds_read_b128 v[96:99], v254 offset:0
    ds_read_b128 v[84:87], v254 offset:272
    v_mfma_f32_16x16x32_bf16 v[148:151], v[52:55], v[184:187], v[148:151]
    ds_read_b128 v[92:95], v254 offset:144
    ds_read_b128 v[100:103], v254 offset:16
    v_mfma_f32_16x16x32_bf16 v[148:151], v[56:59], v[188:191], v[148:151]
    ds_read_b128 v[104:107], v255 offset:192
    ds_read_b128 v[108:111], v255 offset:128
    v_mfma_f32_16x16x32_bf16 v[148:151], v[60:63], v[192:195], v[148:151]
    ds_read_b128 v[112:115], v255 offset:64
    ds_read_b128 v[116:119], v255 offset:0
    v_mfma_f32_16x16x32_bf16 v[148:151], v[64:67], v[196:199], v[148:151]
    ds_read_b128 v[172:175], v1 offset:1504
    ds_read_b128 v[176:179], v1 offset:1440
    v_mfma_f32_16x16x32_bf16 v[148:151], v[68:71], v[200:203], v[148:151]
    ds_read_b128 v[180:183], v1 offset:1376
    ds_read_b128 v[184:187], v1 offset:1312
    s_waitcnt lgkmcnt(13)
    v_mfma_f32_16x16x32_bf16 v[148:151], v[228:231], v[80:83], v[148:151]
    ds_read_b128 v[188:191], v1 offset:1248
    ds_read_b128 v[192:195], v1 offset:1184
    s_waitcnt lgkmcnt(14)
    v_mfma_f32_16x16x32_bf16 v[152:155], v[228:231], v[88:91], v[152:155]
    ds_read_b128 v[196:199], v1 offset:1120
    ds_read_b128 v[200:203], v1 offset:1056
    s_waitcnt lgkmcnt(14)
    v_mfma_f32_16x16x32_bf16 v[156:159], v[228:231], v[96:99], v[156:159]
    ds_read_b128 v[204:207], v1 offset:1488
    v_mfma_f32_16x16x32_bf16 v[148:151], v[232:235], v[84:87], v[148:151]
    s_waitcnt lgkmcnt(11)
    v_mfma_f32_16x16x32_bf16 v[152:155], v[232:235], v[92:95], v[152:155]
    v_mfma_f32_16x16x32_bf16 v[156:159], v[232:235], v[100:103], v[156:159]
    v_mfma_f32_16x16x32_bf16 v[156:159], v[236:239], v[104:107], v[156:159]
    v_mfma_f32_16x16x32_bf16 v[160:163], v[236:239], v[108:111], v[160:163]
    s_waitcnt lgkmcnt(3)
    v_mfma_f32_16x16x32_bf16 v[164:167], v[236:239], v[112:115], 0
    v_mfma_f32_16x16x32_bf16 v[168:171], v[236:239], v[116:119], 0
    v_mfma_f32_16x16x32_bf16 v[148:151], v[8:11], v[172:175], v[148:151]
    v_cvt_pk_bf16_f32 v228, v212, v216
    v_mfma_f32_16x16x32_bf16 v[148:151], v[12:15], v[176:179], v[148:151]
    v_cvt_pk_bf16_f32 v229, v220, v224
    v_mfma_f32_16x16x32_bf16 v[148:151], v[16:19], v[180:183], v[148:151]
    v_cvt_pk_bf16_f32 v230, v213, v217
    v_mfma_f32_16x16x32_bf16 v[148:151], v[20:23], v[184:187], v[148:151]
    v_cvt_pk_bf16_f32 v231, v221, v225
    v_mfma_f32_16x16x32_bf16 v[148:151], v[24:27], v[188:191], v[148:151]
    v_cvt_pk_bf16_f32 v232, v214, v218
    v_mfma_f32_16x16x32_bf16 v[148:151], v[28:31], v[192:195], v[148:151]
    v_cvt_pk_bf16_f32 v233, v222, v226
    s_waitcnt lgkmcnt(0)
    v_mfma_f32_16x16x32_bf16 v[148:151], v[32:35], v[196:199], v[148:151]
    v_cvt_pk_bf16_f32 v234, v215, v219
    v_mfma_f32_16x16x32_bf16 v[148:151], v[36:39], v[200:203], v[148:151]
    v_cvt_pk_bf16_f32 v235, v223, v227
    v_mfma_f32_16x16x32_bf16 v[152:155], v[40:43], v[172:175], v[152:155]
    v_cvt_pk_bf16_f32 v236, v240, v244
    v_mfma_f32_16x16x32_bf16 v[156:159], v[72:75], v[172:175], v[156:159]
    v_cvt_pk_bf16_f32 v237, v241, v245
    v_mfma_f32_16x16x32_bf16 v[164:167], v[76:79], v[172:175], v[164:167]
    v_cvt_pk_bf16_f32 v238, v242, v246
    v_mfma_f32_16x16x32_bf16 v[212:215], v[204:207], v[120:123], 0
    v_cvt_pk_bf16_f32 v239, v243, v247
    v_mfma_f32_16x16x32_bf16 v[216:219], v[172:175], v[124:127], 0
    v_cvt_pk_bf16_f32 v6, v148, v149
    v_mfma_f32_16x16x32_bf16 v[220:223], v[172:175], v[120:123], 0
    v_cvt_pk_bf16_f32 v7, v150, v151
    v_mfma_f32_16x16x32_bf16 v[224:227], v[172:175], v[128:131], 0
    ds_write2st64_b32 v2, v6, v7 offset0:35 offset1:36
    v_mfma_f32_16x16x32_bf16 v[240:243], v[204:207], v[132:135], 0
    ds_add_u32 v208, v5 offset:512
    v_mfma_f32_16x16x32_bf16 v[244:247], v[172:175], v[136:139], 0
    ds_read_b128 v[172:175], v1 offset:2016
    v_mfma_f32_16x16x32_bf16 v[152:155], v[44:47], v[176:179], v[152:155]
    ds_read_b128 v[176:179], v1 offset:1952
    v_mfma_f32_16x16x32_bf16 v[152:155], v[48:51], v[180:183], v[152:155]
    ds_read_b128 v[180:183], v1 offset:1888
    v_mfma_f32_16x16x32_bf16 v[152:155], v[52:55], v[184:187], v[152:155]
    ds_read_b128 v[184:187], v1 offset:1824
    v_mfma_f32_16x16x32_bf16 v[152:155], v[56:59], v[188:191], v[152:155]
    ds_read_b128 v[188:191], v1 offset:1760
    v_mfma_f32_16x16x32_bf16 v[152:155], v[60:63], v[192:195], v[152:155]
    ds_read_b128 v[192:195], v1 offset:1696
    v_mfma_f32_16x16x32_bf16 v[152:155], v[64:67], v[196:199], v[152:155]
    ds_read_b128 v[196:199], v1 offset:1632
    v_mfma_f32_16x16x32_bf16 v[152:155], v[68:71], v[200:203], v[152:155]
    ds_read_b128 v[200:203], v1 offset:1568
    v_mfma_f32_16x16x32_bf16 v[152:155], v[228:231], v[80:83], v[152:155]
    ds_read_b128 v[204:207], v1 offset:2000
    v_mfma_f32_16x16x32_bf16 v[156:159], v[228:231], v[88:91], v[156:159]
    v_mfma_f32_16x16x32_bf16 v[160:163], v[228:231], v[96:99], v[160:163]
    v_mfma_f32_16x16x32_bf16 v[152:155], v[232:235], v[84:87], v[152:155]
    v_mfma_f32_16x16x32_bf16 v[156:159], v[232:235], v[92:95], v[156:159]
    v_mfma_f32_16x16x32_bf16 v[160:163], v[232:235], v[100:103], v[160:163]
    v_mfma_f32_16x16x32_bf16 v[160:163], v[236:239], v[104:107], v[160:163]
    v_mfma_f32_16x16x32_bf16 v[164:167], v[236:239], v[108:111], v[164:167]
    v_mfma_f32_16x16x32_bf16 v[168:171], v[236:239], v[112:115], v[168:171]
    s_waitcnt lgkmcnt(0)
    v_mfma_f32_16x16x32_bf16 v[152:155], v[8:11], v[172:175], v[152:155]
    v_cvt_pk_bf16_f32 v228, v212, v216
    v_mfma_f32_16x16x32_bf16 v[152:155], v[12:15], v[176:179], v[152:155]
    v_cvt_pk_bf16_f32 v229, v220, v224
    v_mfma_f32_16x16x32_bf16 v[152:155], v[16:19], v[180:183], v[152:155]
    v_cvt_pk_bf16_f32 v230, v213, v217
    v_mfma_f32_16x16x32_bf16 v[152:155], v[20:23], v[184:187], v[152:155]
    v_cvt_pk_bf16_f32 v231, v221, v225
    v_mfma_f32_16x16x32_bf16 v[152:155], v[24:27], v[188:191], v[152:155]
    v_cvt_pk_bf16_f32 v232, v214, v218
    v_mfma_f32_16x16x32_bf16 v[152:155], v[28:31], v[192:195], v[152:155]
    v_cvt_pk_bf16_f32 v233, v222, v226
    v_mfma_f32_16x16x32_bf16 v[152:155], v[32:35], v[196:199], v[152:155]
    v_cvt_pk_bf16_f32 v234, v215, v219
    v_mfma_f32_16x16x32_bf16 v[152:155], v[36:39], v[200:203], v[152:155]
    v_cvt_pk_bf16_f32 v235, v223, v227
    v_mfma_f32_16x16x32_bf16 v[156:159], v[40:43], v[172:175], v[156:159]
    ds_read_b32 v209, v210 offset:4
    v_mfma_f32_16x16x32_bf16 v[160:163], v[72:75], v[172:175], v[160:163]
    v_cvt_pk_bf16_f32 v236, v240, v244
    v_mfma_f32_16x16x32_bf16 v[168:171], v[76:79], v[172:175], v[168:171]
    v_cvt_pk_bf16_f32 v237, v241, v245
    v_mfma_f32_16x16x32_bf16 v[212:215], v[204:207], v[120:123], 0
    v_cvt_pk_bf16_f32 v238, v242, v246
    v_mfma_f32_16x16x32_bf16 v[216:219], v[172:175], v[124:127], 0
    v_cvt_pk_bf16_f32 v239, v243, v247
    v_mfma_f32_16x16x32_bf16 v[220:223], v[172:175], v[120:123], 0
    v_cvt_pk_bf16_f32 v6, v152, v153
    v_mfma_f32_16x16x32_bf16 v[224:227], v[172:175], v[128:131], 0
    v_cvt_pk_bf16_f32 v7, v154, v155
    v_mfma_f32_16x16x32_bf16 v[240:243], v[204:207], v[132:135], 0
    ds_write2st64_b32 v2, v6, v7 offset0:37 offset1:38
    v_mfma_f32_16x16x32_bf16 v[244:247], v[172:175], v[136:139], 0
    s_waitcnt lgkmcnt(1)
    v_readfirstlane_b32 s33, v209
    s_cmp_lt_u32 s33, 4
    s_cbranch_scc1 L_ck
L_ck_e:
    v_mfma_f32_16x16x32_bf16 v[156:159], v[44:47], v[176:179], v[156:159]
    ds_add_u32 v208, v5 offset:768
    v_mfma_f32_16x16x32_bf16 v[156:159], v[48:51], v[180:183], v[156:159]
    ds_read_b128 v[172:175], v1 offset:2528
    v_mfma_f32_16x16x32_bf16 v[156:159], v[52:55], v[184:187], v[156:159]
    ds_read_b128 v[176:179], v1 offset:2464
    v_mfma_f32_16x16x32_bf16 v[156:159], v[56:59], v[188:191], v[156:159]
    ds_read_b128 v[180:183], v1 offset:2400
    v_mfma_f32_16x16x32_bf16 v[156:159], v[60:63], v[192:195], v[156:159]
    ds_read_b128 v[184:187], v1 offset:2336
    v_mfma_f32_16x16x32_bf16 v[156:159], v[64:67], v[196:199], v[156:159]
    ds_read_b128 v[188:191], v1 offset:2272
    v_mfma_f32_16x16x32_bf16 v[156:159], v[68:71], v[200:203], v[156:159]
    ds_read_b128 v[192:195], v1 offset:2208
    v_mfma_f32_16x16x32_bf16 v[156:159], v[228:231], v[80:83], v[156:159]
    ds_read_b128 v[196:199], v1 offset:2144
    v_mfma_f32_16x16x32_bf16 v[160:163], v[228:231], v[88:91], v[160:163]
    ds_read_b128 v[200:203], v1 offset:2080
    v_mfma_f32_16x16x32_bf16 v[164:167], v[228:231], v[96:99], v[164:167]
    ds_read_b128 v[204:207], v1 offset:2512
    v_mfma_f32_16x16x32_bf16 v[156:159], v[232:235], v[84:87], v[156:159]
    v_mfma_f32_16x16x32_bf16 v[160:163], v[232:235], v[92:95], v[160:163]
    v_mfma_f32_16x16x32_bf16 v[164:167], v[232:235], v[100:103], v[164:167]
    v_mfma_f32_16x16x32_bf16 v[164:167], v[236:239], v[104:107], v[164:167]
    v_mfma_f32_16x16x32_bf16 v[168:171], v[236:239], v[108:111], v[168:171]
    s_waitcnt lgkmcnt(2)
    v_mfma_f32_16x16x32_bf16 v[156:159], v[8:11], v[172:175], v[156:159]
    v_cvt_pk_bf16_f32 v228, v212, v216
    v_mfma_f32_16x16x32_bf16 v[156:159], v[12:15], v[176:179], v[156:159]
    v_cvt_pk_bf16_f32 v229, v220, v224
    v_mfma_f32_16x16x32_bf16 v[156:159], v[16:19], v[180:183], v[156:159]
    v_cvt_pk_bf16_f32 v230, v213, v217
    v_mfma_f32_16x16x32_bf16 v[156:159], v[20:23], v[184:187], v[156:159]
    v_cvt_pk_bf16_f32 v231, v221, v225
    v_mfma_f32_16x16x32_bf16 v[156:159], v[24:27], v[188:191], v[156:159]
    v_cvt_pk_bf16_f32 v232, v214, v218
    v_mfma_f32_16x16x32_bf16 v[156:159], v[28:31], v[192:195], v[156:159]
    v_cvt_pk_bf16_f32 v233, v222, v226
    v_mfma_f32_16x16x32_bf16 v[156:159], v[32:35], v[196:199], v[156:159]
    v_cvt_pk_bf16_f32 v234, v215, v219
    s_waitcnt lgkmcnt(0)
    v_mfma_f32_16x16x32_bf16 v[156:159], v[36:39], v[200:203], v[156:159]
    v_cvt_pk_bf16_f32 v235, v223, v227
    v_mfma_f32_16x16x32_bf16 v[160:163], v[40:43], v[172:175], v[160:163]
    v_cvt_pk_bf16_f32 v236, v240, v244
    v_mfma_f32_16x16x32_bf16 v[164:167], v[72:75], v[172:175], v[164:167]
    v_cvt_pk_bf16_f32 v237, v241, v245
    v_mfma_f32_16x16x32_bf16 v[212:215], v[204:207], v[120:123], 0
    v_cvt_pk_bf16_f32 v238, v242, v246
    v_mfma_f32_16x16x32_bf16 v[216:219], v[172:175], v[124:127], 0
    v_cvt_pk_bf16_f32 v239, v243, v247
    v_mfma_f32_16x16x32_bf16 v[220:223], v[172:175], v[120:123], 0
    v_cvt_pk_bf16_f32 v6, v156, v157
    v_mfma_f32_16x16x32_bf16 v[224:227], v[172:175], v[128:131], 0
    v_cvt_pk_bf16_f32 v7, v158, v159
    v_mfma_f32_16x16x32_bf16 v[160:163], v[44:47], v[176:179], v[160:163]
    ds_write2st64_b32 v2, v6, v7 offset0:39 offset1:40
    v_mfma_f32_16x16x32_bf16 v[160:163], v[48:51], v[180:183], v[160:163]
    ds_add_u32 v208, v5 offset:1024
    v_mfma_f32_16x16x32_bf16 v[160:163], v[52:55], v[184:187], v[160:163]
    ds_read_b128 v[172:175], v1 offset:3040
    v_mfma_f32_16x16x32_bf16 v[160:163], v[56:59], v[188:191], v[160:163]
    ds_read_b128 v[176:179], v1 offset:2976
    v_mfma_f32_16x16x32_bf16 v[160:163], v[60:63], v[192:195], v[160:163]
    ds_read_b128 v[180:183], v1 offset:2912
    v_mfma_f32_16x16x32_bf16 v[160:163], v[64:67], v[196:199], v[160:163]
    ds_read_b128 v[184:187], v1 offset:2848
    v_mfma_f32_16x16x32_bf16 v[160:163], v[68:71], v[200:203], v[160:163]
    ds_read_b128 v[188:191], v1 offset:2784
    v_mfma_f32_16x16x32_bf16 v[160:163], v[228:231], v[80:83], v[160:163]
    ds_read_b128 v[192:195], v1 offset:2720
    v_mfma_f32_16x16x32_bf16 v[164:167], v[228:231], v[88:91], v[164:167]
    ds_read_b128 v[196:199], v1 offset:2656
    v_mfma_f32_16x16x32_bf16 v[168:171], v[228:231], v[96:99], v[168:171]
    ds_read_b128 v[200:203], v1 offset:2592
    v_mfma_f32_16x16x32_bf16 v[160:163], v[232:235], v[84:87], v[160:163]
    ds_read_b128 v[204:207], v1 offset:3024
    v_mfma_f32_16x16x32_bf16 v[164:167], v[232:235], v[92:95], v[164:167]
    v_mfma_f32_16x16x32_bf16 v[168:171], v[232:235], v[100:103], v[168:171]
    v_mfma_f32_16x16x32_bf16 v[168:171], v[236:239], v[104:107], v[168:171]
    s_waitcnt lgkmcnt(4)
    v_mfma_f32_16x16x32_bf16 v[160:163], v[8:11], v[172:175], v[160:163]
    ds_read_b128 v[104:107], v1 offset:3552
    v_cvt_pk_bf16_f32 v228, v212, v216
    v_mfma_f32_16x16x32_bf16 v[160:163], v[12:15], v[176:179], v[160:163]
    v_cvt_pk_bf16_f32 v229, v220, v224
    v_cvt_pk_bf16_f32 v230, v213, v217
    v_mfma_f32_16x16x32_bf16 v[160:163], v[16:19], v[180:183], v[160:163]
    v_cvt_pk_bf16_f32 v231, v221, v225
    v_cvt_pk_bf16_f32 v232, v214, v218
    v_mfma_f32_16x16x32_bf16 v[160:163], v[20:23], v[184:187], v[160:163]
    v_cvt_pk_bf16_f32 v233, v222, v226
    v_cvt_pk_bf16_f32 v234, v215, v219
    v_mfma_f32_16x16x32_bf16 v[160:163], v[24:27], v[188:191], v[160:163]
    v_cvt_pk_bf16_f32 v235, v223, v227
    ds_read_b128 v[108:111], v1 offset:3488
    s_waitcnt lgkmcnt(2)
    v_mfma_f32_16x16x32_bf16 v[160:163], v[28:31], v[192:195], v[160:163]
    ds_read_b128 v[112:115], v1 offset:3424
    ds_read_b128 v[116:119], v1 offset:3360
    v_mfma_f32_16x16x32_bf16 v[160:163], v[32:35], v[196:199], v[160:163]
    ds_read_b128 v[132:135], v1 offset:3296
    ds_read_b128 v[136:139], v1 offset:3232
    v_mfma_f32_16x16x32_bf16 v[160:163], v[36:39], v[200:203], v[160:163]
    ds_read_b128 v[240:243], v1 offset:3168
    ds_read_b128 v[244:247], v1 offset:3104
    v_mfma_f32_16x16x32_bf16 v[164:167], v[40:43], v[172:175], v[164:167]
    v_mfma_f32_16x16x32_bf16 v[164:167], v[44:47], v[176:179], v[164:167]
    v_mfma_f32_16x16x32_bf16 v[164:167], v[48:51], v[180:183], v[164:167]
    v_mfma_f32_16x16x32_bf16 v[164:167], v[52:55], v[184:187], v[164:167]
    v_mfma_f32_16x16x32_bf16 v[164:167], v[56:59], v[188:191], v[164:167]
    v_mfma_f32_16x16x32_bf16 v[164:167], v[60:63], v[192:195], v[164:167]
    v_cvt_pk_bf16_f32 v6, v160, v161
    v_mfma_f32_16x16x32_bf16 v[164:167], v[64:67], v[196:199], v[164:167]
    v_cvt_pk_bf16_f32 v7, v162, v163
    v_mfma_f32_16x16x32_bf16 v[164:167], v[68:71], v[200:203], v[164:167]
    ds_write2st64_b32 v2, v6, v7 offset0:41 offset1:42
    v_mfma_f32_16x16x32_bf16 v[164:167], v[228:231], v[80:83], v[164:167]
    ds_add_u32 v208, v5 offset:1280
    v_mfma_f32_16x16x32_bf16 v[164:167], v[232:235], v[84:87], v[164:167]
    ds_read_b128 v[176:179], v1 offset:4000
    s_waitcnt lgkmcnt(3)
    v_mfma_f32_16x16x32_bf16 v[164:167], v[8:11], v[104:107], v[164:167]
    ds_read_b128 v[180:183], v1 offset:3936
    v_mfma_f32_16x16x32_bf16 v[164:167], v[12:15], v[108:111], v[164:167]
    ds_read_b128 v[184:187], v1 offset:3872
    v_mfma_f32_16x16x32_bf16 v[164:167], v[16:19], v[112:115], v[164:167]
    ds_read_b128 v[188:191], v1 offset:3808
    v_mfma_f32_16x16x32_bf16 v[164:167], v[20:23], v[116:119], v[164:167]
    ds_read_b128 v[192:195], v1 offset:3744
    v_mfma_f32_16x16x32_bf16 v[164:167], v[24:27], v[132:135], v[164:167]
    ds_read_b128 v[196:199], v1 offset:3680
    v_mfma_f32_16x16x32_bf16 v[164:167], v[28:31], v[136:139], v[164:167]
    ds_read_b128 v[200:203], v1 offset:3616
    v_mfma_f32_16x16x32_bf16 v[164:167], v[32:35], v[240:243], v[164:167]
    v_mfma_f32_16x16x32_bf16 v[164:167], v[36:39], v[244:247], v[164:167]
    v_mfma_f32_16x16x32_bf16 v[168:171], v[228:231], v[88:91], v[168:171]
    v_mfma_f32_16x16x32_bf16 v[168:171], v[232:235], v[92:95], v[168:171]
    v_mfma_f32_16x16x32_bf16 v[168:171], v[72:75], v[172:175], v[168:171]
    v_mfma_f32_16x16x32_bf16 v[212:215], v[204:207], v[120:123], 0
    v_mfma_f32_16x16x32_bf16 v[216:219], v[172:175], v[124:127], 0
    s_nop 2
    v_cvt_pk_bf16_f32 v6, v164, v165
    v_mfma_f32_16x16x32_bf16 v[220:223], v[172:175], v[120:123], 0
    v_cvt_pk_bf16_f32 v7, v166, v167
    v_mfma_f32_16x16x32_bf16 v[224:227], v[172:175], v[128:131], 0
    ds_write2st64_b32 v2, v6, v7 offset0:43 offset1:44
    v_mfma_f32_16x16x32_bf16 v[168:171], v[40:43], v[104:107], v[168:171]
    ds_add_u32 v208, v5 offset:1536
    v_mfma_f32_16x16x32_bf16 v[168:171], v[44:47], v[108:111], v[168:171]
    ds_read_b128 v[172:175], v1 offset:4064
    v_mfma_f32_16x16x32_bf16 v[168:171], v[48:51], v[112:115], v[168:171]
    v_mfma_f32_16x16x32_bf16 v[168:171], v[52:55], v[116:119], v[168:171]
    v_mfma_f32_16x16x32_bf16 v[168:171], v[56:59], v[132:135], v[168:171]
    v_mfma_f32_16x16x32_bf16 v[168:171], v[60:63], v[136:139], v[168:171]
    v_cvt_pk_bf16_f32 v228, v212, v216
    v_mfma_f32_16x16x32_bf16 v[168:171], v[64:67], v[240:243], v[168:171]
    v_cvt_pk_bf16_f32 v229, v220, v224
    v_mfma_f32_16x16x32_bf16 v[168:171], v[68:71], v[244:247], v[168:171]
    v_cvt_pk_bf16_f32 v230, v213, v217
    s_waitcnt lgkmcnt(1)
    v_mfma_f32_16x16x32_bf16 v[168:171], v[12:15], v[176:179], v[168:171]
    v_cvt_pk_bf16_f32 v231, v221, v225
    v_mfma_f32_16x16x32_bf16 v[168:171], v[16:19], v[180:183], v[168:171]
    v_cvt_pk_bf16_f32 v232, v214, v218
    v_mfma_f32_16x16x32_bf16 v[168:171], v[20:23], v[184:187], v[168:171]
    v_cvt_pk_bf16_f32 v233, v222, v226
    v_mfma_f32_16x16x32_bf16 v[168:171], v[24:27], v[188:191], v[168:171]
    v_cvt_pk_bf16_f32 v234, v215, v219
    v_mfma_f32_16x16x32_bf16 v[168:171], v[28:31], v[192:195], v[168:171]
    v_cvt_pk_bf16_f32 v235, v223, v227
    v_mfma_f32_16x16x32_bf16 v[168:171], v[32:35], v[196:199], v[168:171]
    v_mfma_f32_16x16x32_bf16 v[168:171], v[36:39], v[200:203], v[168:171]
    s_waitcnt lgkmcnt(0)
    v_mfma_f32_16x16x32_bf16 v[168:171], v[8:11], v[172:175], v[168:171]
    v_mfma_f32_16x16x32_bf16 v[168:171], v[228:231], v[80:83], v[168:171]
    v_mfma_f32_16x16x32_bf16 v[168:171], v[232:235], v[84:87], v[168:171]
    s_nop 7
    v_cvt_pk_bf16_f32 v6, v168, v169
    v_cvt_pk_bf16_f32 v7, v170, v171
    ds_write2st64_b32 v2, v6, v7 offset0:45 offset1:46
    ds_add_u32 v208, v5 offset:1792
    s_branch L_fin
L_pollm:
    ds_read_b32 v213, v210 offset:0
    s_waitcnt lgkmcnt(0)
    v_readfirstlane_b32 s33, v213
    s_cmp_lt_u32 s33, 4
    s_cbranch_scc0 L_pollm_e
    s_sub_u32 s53, s53, 1
    s_cbranch_scc0 L_pollm
    s_endpgm
L_ck:
    ds_read_b32 v209, v210 offset:4
    s_waitcnt lgkmcnt(0)
    v_readfirstlane_b32 s33, v209
    s_cmp_lt_u32 s33, 4
    s_cbranch_scc0 L_ck_e
    s_sub_u32 s53, s53, 1
    s_cbranch_scc0 L_ck
    s_endpgm
L_near:
    s_add_u32 s33, s29, 23424
    v_add_u32 v206, s33, v5
    v_cndmask_b32 v5, 0, 1, vcc
    s_lshl_b32 s33, s59, 2
    s_add_u32 s33, s33, 157696
    v_mov_b32 v225, s33
    v_mov_b32 v226, 157704
    v_mov_b32 v227, v165
    ds_read_b32 v224, v210 offset:0
    s_waitcnt lgkmcnt(0)
    v_readfirstlane_b32 s33, v224
    s_cmp_lt_u32 s33, 4
    s_cbranch_scc1 L_polln
L_polln_e:
    ds_read_b128 v[72:75], v1 offset:480
    ds_read_b128 v[76:79], v1 offset:416
    ds_read_b128 v[80:83], v1 offset:352
    ds_read_b128 v[84:87], v1 offset:288
    ds_read_b128 v[88:91], v1 offset:224
    ds_read_b128 v[92:95], v1 offset:160
    ds_read_b128 v[96:99], v1 offset:96
    ds_read_b128 v[100:103], v1 offset:32
    v_and_or_b32 v8, s44, v240, v8
    v_and_or_b32 v9, s44, v241, v9
    v_and_or_b32 v10, s44, v242, v10
    v_and_or_b32 v11, s44, v243, v11
    s_waitcnt lgkmcnt(7)
    s_nop 0
    v_mfma_f32_16x16x32_bf16 v[140:143], v[8:11], v[72:75], 0
    s_waitcnt lgkmcnt(6)
    v_mfma_f32_16x16x32_bf16 v[140:143], v[12:15], v[76:79], v[140:143]
    s_waitcnt lgkmcnt(5)
    v_mfma_f32_16x16x32_bf16 v[140:143], v[16:19], v[80:83], v[140:143]
    s_waitcnt lgkmcnt(4)
    v_mfma_f32_16x16x32_bf16 v[140:143], v[20:23], v[84:87], v[140:143]
    s_waitcnt lgkmcnt(3)
    v_mfma_f32_16x16x32_bf16 v[140:143], v[24:27], v[88:91], v[140:143]
    s_waitcnt lgkmcnt(2)
    v_mfma_f32_16x16x32_bf16 v[140:143], v[28:31], v[92:95], v[140:143]
    s_waitcnt lgkmcnt(1)
    v_mfma_f32_16x16x32_bf16 v[140:143], v[32:35], v[96:99], v[140:143]
    s_waitcnt lgkmcnt(0)
    v_mfma_f32_16x16x32_bf16 v[140:143], v[36:39], v[100:103], v[140:143]
    ds_write_b64 v228, v[160:161] offset:64
    ds_write2_b32 v230, v160, v161 offset0:15 offset1:16
    ds_write2_b32 v229, v162, v163 offset0:15 offset1:16
    ds_write_b64 v228, v[162:163] offset:3704
    s_nop 3
    v_cvt_pk_bf16_f32 v6, v140, v141
    v_cvt_pk_bf16_f32 v7, v142, v143
    ds_write2st64_b32 v2, v6, v7 offset0:31 offset1:32
    ds_add_u32 v208, v5 offset:0
    ds_read_b64 v[40:41], v237 offset:512
    ds_read_b64 v[42:43], v237 offset:520
    ds_read_b64 v[44:45], v237 offset:448
    ds_read_b64 v[46:47], v237 offset:456
    ds_read_b64 v[48:49], v237 offset:384
    ds_read_b64 v[50:51], v237 offset:392
    ds_read_b64 v[52:53], v237 offset:320
    ds_read_b64 v[54:55], v237 offset:328
    ds_read_b64 v[56:57], v237 offset:256
    ds_read_b64 v[58:59], v237 offset:264
    ds_read_b64 v[60:61], v237 offset:192
    ds_read_b64 v[62:63], v237 offset:200
    ds_read_b64 v[64:65], v237 offset:128
    ds_read_b64 v[66:67], v237 offset:136
    ds_read_b64 v[68:69], v237 offset:64
    ds_read_b64 v[70:71], v237 offset:72
    s_waitcnt lgkmcnt(14)
    v_mfma_f32_16x16x32_bf16 v[144:147], v[40:43], v[72:75], 0
    ds_read_b128 v[104:107], v1 offset:992
    s_waitcnt lgkmcnt(13)
    v_mfma_f32_16x16x32_bf16 v[144:147], v[44:47], v[76:79], v[144:147]
    ds_read_b128 v[108:111], v1 offset:928
    s_waitcnt lgkmcnt(12)
    v_mfma_f32_16x16x32_bf16 v[144:147], v[48:51], v[80:83], v[144:147]
    ds_read_b128 v[112:115], v1 offset:864
    s_waitcnt lgkmcnt(11)
    v_mfma_f32_16x16x32_bf16 v[144:147], v[52:55], v[84:87], v[144:147]
    ds_read_b128 v[116:119], v1 offset:800
    s_waitcnt lgkmcnt(10)
    v_mfma_f32_16x16x32_bf16 v[144:147], v[56:59], v[88:91], v[144:147]
    ds_read_b128 v[120:123], v1 offset:736
    s_waitcnt lgkmcnt(9)
    v_mfma_f32_16x16x32_bf16 v[144:147], v[60:63], v[92:95], v[144:147]
    ds_read_b128 v[124:127], v1 offset:672
    s_waitcnt lgkmcnt(8)
    v_mfma_f32_16x16x32_bf16 v[144:147], v[64:67], v[96:99], v[144:147]
    ds_read_b128 v[128:131], v1 offset:608
    s_waitcnt lgkmcnt(7)
    v_mfma_f32_16x16x32_bf16 v[144:147], v[68:71], v[100:103], v[144:147]
    ds_read_b128 v[132:135], v1 offset:544
    s_waitcnt lgkmcnt(7)
    v_mfma_f32_16x16x32_bf16 v[144:147], v[8:11], v[104:107], v[144:147]
    ds_read_b128 v[72:75], v1 offset:1504
    s_waitcnt lgkmcnt(7)
    v_mfma_f32_16x16x32_bf16 v[144:147], v[12:15], v[108:111], v[144:147]
    ds_read_b128 v[76:79], v1 offset:1440
    s_waitcnt lgkmcnt(7)
    v_mfma_f32_16x16x32_bf16 v[144:147], v[16:19], v[112:115], v[144:147]
    ds_read_b128 v[80:83], v1 offset:1376
    s_waitcnt lgkmcnt(7)
    v_mfma_f32_16x16x32_bf16 v[144:147], v[20:23], v[116:119], v[144:147]
    ds_read_b128 v[84:87], v1 offset:1312
    s_waitcnt lgkmcnt(7)
    v_mfma_f32_16x16x32_bf16 v[144:147], v[24:27], v[120:123], v[144:147]
    ds_read_b128 v[88:91], v1 offset:1248
    s_waitcnt lgkmcnt(7)
    v_mfma_f32_16x16x32_bf16 v[144:147], v[28:31], v[124:127], v[144:147]
    s_waitcnt lgkmcnt(6)
    v_mfma_f32_16x16x32_bf16 v[144:147], v[32:35], v[128:131], v[144:147]
    ds_read_b128 v[92:95], v1 offset:1184
    s_waitcnt lgkmcnt(6)
    v_mfma_f32_16x16x32_bf16 v[144:147], v[36:39], v[132:135], v[144:147]
    ds_read_b128 v[96:99], v1 offset:1120
    v_mfma_f32_16x16x32_bf16 v[148:151], v[40:43], v[104:107], 0
    ds_read_b128 v[100:103], v1 offset:1056
    v_mfma_f32_16x16x32_bf16 v[148:151], v[44:47], v[108:111], v[148:151]
    v_mfma_f32_16x16x32_bf16 v[148:151], v[48:51], v[112:115], v[148:151]
    v_mfma_f32_16x16x32_bf16 v[148:151], v[52:55], v[116:119], v[148:151]
    s_nop 1
    v_cvt_pk_bf16_f32 v6, v144, v145
    v_cvt_pk_bf16_f32 v7, v146, v147
    ds_write2st64_b32 v2, v6, v7 offset0:33 offset1:34
    ds_add_u32 v208, v5 offset:256
    v_mfma_f32_16x16x32_bf16 v[148:151], v[56:59], v[120:123], v[148:151]
    s_setprio 0
    s_waitcnt vmcnt(0)
    v_perm_b32 v212, v192, v188, s40
    v_perm_b32 v213, v200, v196, s40
    ds_write_b64 v253, v[212:213] offset:2048
    v_perm_b32 v214, v192, v188, s41
    v_perm_b32 v215, v200, v196, s41
    ds_write_b64 v253, v[214:215] offset:6656
    v_perm_b32 v216, v193, v189, s40
    v_perm_b32 v217, v201, v197, s40
    ds_write_b64 v253, v[216:217] offset:11264
    v_perm_b32 v218, v193, v189, s41
    v_perm_b32 v219, v201, v197, s41
    ds_write_b64 v253, v[218:219] offset:15872
    v_perm_b32 v220, v194, v190, s40
    v_perm_b32 v221, v202, v198, s40
    ds_write_b64 v253, v[220:221] offset:20480
    v_perm_b32 v222, v194, v190, s41
    v_perm_b32 v223, v202, v198, s41
    ds_write_b64 v253, v[222:223] offset:25088
    ds_add_u32 v208, v227 offset:2052
    s_setprio 2
    s_setprio 2
    s_cmp_lg_u32 s59, 0
    s_cbranch_scc1 L_fd0
    ds_read_b32 v224, v226 offset:0
    s_waitcnt lgkmcnt(0)
    v_readfirstlane_b32 s33, v224
    s_cmp_lt_u32 s33, 6
    s_cbranch_scc1 L_fp0
L_fp0_e:
    s_setprio 2
    ds_read_b32 v212, v3 offset:0
    ds_read_b32 v213, v3 offset:256
    ds_read_b32 v214, v3 offset:15232
    ds_read_b32 v215, v3 offset:15488
    ds_read_b32 v216, v3 offset:30464
    ds_read_b32 v217, v3 offset:30720
    ds_read_b32 v218, v3 offset:45696
    ds_read_b32 v219, v3 offset:45952
    ds_read_b32 v220, v211 offset:0
    ds_read_b32 v221, v211 offset:256
    ds_read_b32 v222, v211 offset:30464
    ds_read_b32 v223, v211 offset:30720
    s_add_u32 s50, s24, 0
    s_addc_u32 s51, s25, 0
    s_waitcnt lgkmcnt(0)
    v_perm_b32 v172, v214, v212, s40
    v_perm_b32 v173, v218, v216, s40
    v_perm_b32 v174, v222, v220, s40
    global_store_dwordx3 v179, v[172:174], s[50:51] offset:-3456
    v_perm_b32 v176, v214, v212, s41
    v_perm_b32 v177, v218, v216, s41
    v_perm_b32 v178, v222, v220, s41
    global_store_dwordx3 v179, v[176:178], s[50:51] offset:-1152
    v_perm_b32 v180, v215, v213, s40
    v_perm_b32 v181, v219, v217, s40
    v_perm_b32 v182, v223, v221, s40
    global_store_dwordx3 v179, v[180:182], s[50:51] offset:1152
    v_perm_b32 v184, v215, v213, s41
    v_perm_b32 v185, v219, v217, s41
    v_perm_b32 v186, v223, v221, s41
    global_store_dwordx3 v179, v[184:186], s[50:51] offset:3456
L_fd0:
    s_waitcnt lgkmcnt(12)
    v_mfma_f32_16x16x32_bf16 v[148:151], v[8:11], v[72:75], v[148:151]
    ds_read_b32 v224, v225 offset:512
    ds_read_b128 v[104:107], v1 offset:2016
    v_mfma_f32_16x16x32_bf16 v[148:151], v[12:15], v[76:79], v[148:151]
    ds_read_b128 v[108:111], v1 offset:1952
    v_mfma_f32_16x16x32_bf16 v[148:151], v[16:19], v[80:83], v[148:151]
    ds_read_b128 v[112:115], v1 offset:1888
    v_mfma_f32_16x16x32_bf16 v[148:151], v[20:23], v[84:87], v[148:151]
    ds_read_b128 v[116:119], v1 offset:1824
    v_mfma_f32_16x16x32_bf16 v[148:151], v[24:27], v[88:91], v[148:151]
    ds_read_b128 v[120:123], v1 offset:1760
    s_waitcnt lgkmcnt(15)
    v_mfma_f32_16x16x32_bf16 v[148:151], v[28:31], v[92:95], v[148:151]
    s_waitcnt lgkmcnt(5)
    v_readfirstlane_b32 s33, v224
    s_cmp_lt_u32 s33, 1
    s_cbranch_scc1 L_pn2
L_pn2_e:
    ds_read_b128 v[136:139], v206 offset:0
    v_mfma_f32_16x16x32_bf16 v[148:151], v[32:35], v[96:99], v[148:151]
    ds_read_b128 v[124:127], v1 offset:1696
    v_mfma_f32_16x16x32_bf16 v[148:151], v[36:39], v[100:103], v[148:151]
    ds_read_b128 v[128:131], v1 offset:1632
    v_mfma_f32_16x16x32_bf16 v[152:155], v[40:43], v[72:75], 0
    ds_read_b128 v[132:135], v1 offset:1568
    v_mfma_f32_16x16x32_bf16 v[152:155], v[44:47], v[76:79], v[152:155]
    v_mfma_f32_16x16x32_bf16 v[152:155], v[48:51], v[80:83], v[152:155]
    v_mfma_f32_16x16x32_bf16 v[152:155], v[52:55], v[84:87], v[152:155]
    s_waitcnt lgkmcnt(3)
    s_nop 0
    v_add_f32 v148, v148, v136
    v_add_f32 v149, v149, v137
    v_add_f32 v150, v150, v138
    v_add_f32 v151, v151, v139
    v_cvt_pk_bf16_f32 v6, v148, v149
    v_cvt_pk_bf16_f32 v7, v150, v151
    ds_write2st64_b32 v2, v6, v7 offset0:35 offset1:36
    ds_add_u32 v208, v5 offset:512
    v_mfma_f32_16x16x32_bf16 v[152:155], v[56:59], v[88:91], v[152:155]
    v_mfma_f32_16x16x32_bf16 v[152:155], v[8:11], v[104:107], v[152:155]
    ds_read_b32 v224, v210 offset:4
    s_waitcnt lgkmcnt(0)
    v_readfirstlane_b32 s33, v224
    s_cmp_lt_u32 s33, 4
    s_cbranch_scc1 L_un
L_un_e:
    ds_read_b32 v224, v225 offset:768
    ds_read_b128 v[72:75], v1 offset:2528
    v_mfma_f32_16x16x32_bf16 v[152:155], v[12:15], v[108:111], v[152:155]
    ds_read_b128 v[76:79], v1 offset:2464
    v_mfma_f32_16x16x32_bf16 v[152:155], v[16:19], v[112:115], v[152:155]
    ds_read_b128 v[80:83], v1 offset:2400
    v_mfma_f32_16x16x32_bf16 v[152:155], v[20:23], v[116:119], v[152:155]
    ds_read_b128 v[84:87], v1 offset:2336
    v_mfma_f32_16x16x32_bf16 v[152:155], v[24:27], v[120:123], v[152:155]
    ds_read_b128 v[88:91], v1 offset:2272
    v_mfma_f32_16x16x32_bf16 v[152:155], v[28:31], v[124:127], v[152:155]
    s_waitcnt lgkmcnt(5)
    v_readfirstlane_b32 s33, v224
    s_cmp_lt_u32 s33, 1
    s_cbranch_scc1 L_pn3
L_pn3_e:
    ds_read_b128 v[136:139], v206 offset:1024
    v_mfma_f32_16x16x32_bf16 v[152:155], v[32:35], v[128:131], v[152:155]
    ds_read_b128 v[92:95], v1 offset:2208
    v_mfma_f32_16x16x32_bf16 v[152:155], v[36:39], v[132:135], v[152:155]
    ds_read_b128 v[96:99], v1 offset:2144
    v_mfma_f32_16x16x32_bf16 v[156:159], v[40:43], v[104:107], 0
    ds_read_b128 v[100:103], v1 offset:2080
    v_mfma_f32_16x16x32_bf16 v[156:159], v[44:47], v[108:111], v[156:159]
    v_mfma_f32_16x16x32_bf16 v[156:159], v[48:51], v[112:115], v[156:159]
    v_mfma_f32_16x16x32_bf16 v[156:159], v[52:55], v[116:119], v[156:159]
    s_waitcnt lgkmcnt(3)
    s_nop 0
    v_add_f32 v152, v152, v136
    v_add_f32 v153, v153, v137
    v_add_f32 v154, v154, v138
    v_add_f32 v155, v155, v139
    v_cvt_pk_bf16_f32 v6, v152, v153
    v_cvt_pk_bf16_f32 v7, v154, v155
    ds_write2st64_b32 v2, v6, v7 offset0:37 offset1:38
    ds_add_u32 v208, v5 offset:768
    v_mfma_f32_16x16x32_bf16 v[156:159], v[56:59], v[120:123], v[156:159]
    s_cmp_lg_u32 s59, 1
    s_cbranch_scc1 L_fd2
    ds_read_b32 v224, v226 offset:512
    s_waitcnt lgkmcnt(0)
    v_readfirstlane_b32 s33, v224
    s_cmp_lt_u32 s33, 6
    s_cbranch_scc1 L_fp2
L_fp2_e:
    ds_read_b32 v212, v3 offset:1024
    ds_read_b32 v213, v3 offset:1280
    ds_read_b32 v214, v3 offset:16256
    ds_read_b32 v215, v3 offset:16512
    ds_read_b32 v216, v3 offset:31488
    ds_read_b32 v217, v3 offset:31744
    ds_read_b32 v218, v3 offset:46720
    ds_read_b32 v219, v3 offset:46976
    ds_read_b32 v220, v211 offset:1024
    ds_read_b32 v221, v211 offset:1280
    ds_read_b32 v222, v211 offset:31488
    ds_read_b32 v223, v211 offset:31744
    s_add_u32 s50, s24, 1179648
    s_addc_u32 s51, s25, 0
    s_waitcnt lgkmcnt(0)
    v_perm_b32 v172, v214, v212, s40
    v_perm_b32 v173, v218, v216, s40
    v_perm_b32 v174, v222, v220, s40
    global_store_dwordx3 v179, v[172:174], s[50:51] offset:-3456
    v_perm_b32 v176, v214, v212, s41
    v_perm_b32 v177, v218, v216, s41
    v_perm_b32 v178, v222, v220, s41
    global_store_dwordx3 v179, v[176:178], s[50:51] offset:-1152
    v_perm_b32 v180, v215, v213, s40
    v_perm_b32 v181, v219, v217, s40
    v_perm_b32 v182, v223, v221, s40
    global_store_dwordx3 v179, v[180:182], s[50:51] offset:1152
    v_perm_b32 v184, v215, v213, s41
    v_perm_b32 v185, v219, v217, s41
    v_perm_b32 v186, v223, v221, s41
    global_store_dwordx3 v179, v[184:186], s[50:51] offset:3456
L_fd2:
    v_mfma_f32_16x16x32_bf16 v[156:159], v[8:11], v[72:75], v[156:159]
    ds_read_b32 v224, v225 offset:1024
    ds_read_b128 v[104:107], v1 offset:3040
    v_mfma_f32_16x16x32_bf16 v[156:159], v[12:15], v[76:79], v[156:159]
    ds_read_b128 v[108:111], v1 offset:2976
    v_mfma_f32_16x16x32_bf16 v[156:159], v[16:19], v[80:83], v[156:159]
    ds_read_b128 v[112:115], v1 offset:2912
    v_mfma_f32_16x16x32_bf16 v[156:159], v[20:23], v[84:87], v[156:159]
    ds_read_b128 v[116:119], v1 offset:2848
    v_mfma_f32_16x16x32_bf16 v[156:159], v[24:27], v[88:91], v[156:159]
    ds_read_b128 v[120:123], v1 offset:2784
    s_waitcnt lgkmcnt(8)
    v_mfma_f32_16x16x32_bf16 v[156:159], v[28:31], v[92:95], v[156:159]
    s_waitcnt lgkmcnt(5)
    v_readfirstlane_b32 s33, v224
    s_cmp_lt_u32 s33, 1
    s_cbranch_scc1 L_pn4
L_pn4_e:
    ds_read_b128 v[136:139], v206 offset:2048
    v_mfma_f32_16x16x32_bf16 v[156:159], v[32:35], v[96:99], v[156:159]
    ds_read_b128 v[124:127], v1 offset:2720
    v_mfma_f32_16x16x32_bf16 v[156:159], v[36:39], v[100:103], v[156:159]
    ds_read_b128 v[128:131], v1 offset:2656
    v_mfma_f32_16x16x32_bf16 v[160:163], v[40:43], v[72:75], 0
    ds_read_b128 v[132:135], v1 offset:2592
    v_mfma_f32_16x16x32_bf16 v[160:163], v[44:47], v[76:79], v[160:163]
    v_mfma_f32_16x16x32_bf16 v[160:163], v[48:51], v[80:83], v[160:163]
    v_mfma_f32_16x16x32_bf16 v[160:163], v[52:55], v[84:87], v[160:163]
    s_waitcnt lgkmcnt(3)
    s_nop 0
    v_add_f32 v156, v156, v136
    v_add_f32 v157, v157, v137
    v_add_f32 v158, v158, v138
    v_add_f32 v159, v159, v139
    v_cvt_pk_bf16_f32 v6, v156, v157
    v_cvt_pk_bf16_f32 v7, v158, v159
    ds_write2st64_b32 v2, v6, v7 offset0:39 offset1:40
    ds_add_u32 v208, v5 offset:1024
    v_mfma_f32_16x16x32_bf16 v[160:163], v[56:59], v[88:91], v[160:163]
    v_mfma_f32_16x16x32_bf16 v[160:163], v[8:11], v[104:107], v[160:163]
    ds_read_b32 v224, v225 offset:1280
    ds_read_b128 v[72:75], v1 offset:3552
    v_mfma_f32_16x16x32_bf16 v[160:163], v[12:15], v[108:111], v[160:163]
    ds_read_b128 v[76:79], v1 offset:3488
    v_mfma_f32_16x16x32_bf16 v[160:163], v[16:19], v[112:115], v[160:163]
    ds_read_b128 v[80:83], v1 offset:3424
    v_mfma_f32_16x16x32_bf16 v[160:163], v[20:23], v[116:119], v[160:163]
    ds_read_b128 v[84:87], v1 offset:3360
    v_mfma_f32_16x16x32_bf16 v[160:163], v[24:27], v[120:123], v[160:163]
    ds_read_b128 v[88:91], v1 offset:3296
    s_waitcnt lgkmcnt(8)
    v_mfma_f32_16x16x32_bf16 v[160:163], v[28:31], v[124:127], v[160:163]
    s_waitcnt lgkmcnt(5)
    v_readfirstlane_b32 s33, v224
    s_cmp_lt_u32 s33, 1
    s_cbranch_scc1 L_pn5
L_pn5_e:
    ds_read_b128 v[136:139], v206 offset:3072
    v_mfma_f32_16x16x32_bf16 v[160:163], v[32:35], v[128:131], v[160:163]
    ds_read_b128 v[92:95], v1 offset:3232
    v_mfma_f32_16x16x32_bf16 v[160:163], v[36:39], v[132:135], v[160:163]
    ds_read_b128 v[96:99], v1 offset:3168
    v_mfma_f32_16x16x32_bf16 v[164:167], v[40:43], v[104:107], 0
    ds_read_b128 v[100:103], v1 offset:3104
    v_mfma_f32_16x16x32_bf16 v[164:167], v[44:47], v[108:111], v[164:167]
    v_mfma_f32_16x16x32_bf16 v[164:167], v[48:51], v[112:115], v[164:167]
    v_mfma_f32_16x16x32_bf16 v[164:167], v[52:55], v[116:119], v[164:167]
    s_waitcnt lgkmcnt(3)
    s_nop 0
    v_add_f32 v160, v160, v136
    v_add_f32 v161, v161, v137
    v_add_f32 v162, v162, v138
    v_add_f32 v163, v163, v139
    v_cvt_pk_bf16_f32 v6, v160, v161
    v_cvt_pk_bf16_f32 v7, v162, v163
    ds_write2st64_b32 v2, v6, v7 offset0:41 offset1:42
    ds_add_u32 v208, v5 offset:1280
    v_mfma_f32_16x16x32_bf16 v[164:167], v[56:59], v[120:123], v[164:167]
    v_mfma_f32_16x16x32_bf16 v[164:167], v[8:11], v[72:75], v[164:167]
    ds_read_b32 v224, v225 offset:1536
    ds_read_b128 v[104:107], v1 offset:4064
    v_mfma_f32_16x16x32_bf16 v[164:167], v[12:15], v[76:79], v[164:167]
    ds_read_b128 v[108:111], v1 offset:4000
    v_mfma_f32_16x16x32_bf16 v[164:167], v[16:19], v[80:83], v[164:167]
    ds_read_b128 v[112:115], v1 offset:3936
    v_mfma_f32_16x16x32_bf16 v[164:167], v[20:23], v[84:87], v[164:167]
    ds_read_b128 v[116:119], v1 offset:3872
    v_mfma_f32_16x16x32_bf16 v[164:167], v[24:27], v[88:91], v[164:167]
    ds_read_b128 v[120:123], v1 offset:3808
    s_waitcnt lgkmcnt(8)
    v_mfma_f32_16x16x32_bf16 v[164:167], v[28:31], v[92:95], v[164:167]
    s_waitcnt lgkmcnt(5)
    v_readfirstlane_b32 s33, v224
    s_cmp_lt_u32 s33, 1
    s_cbranch_scc1 L_pn6
L_pn6_e:
    ds_read_b128 v[136:139], v206 offset:4096
    v_mfma_f32_16x16x32_bf16 v[164:167], v[32:35], v[96:99], v[164:167]
    ds_read_b128 v[124:127], v1 offset:3744
    v_mfma_f32_16x16x32_bf16 v[164:167], v[36:39], v[100:103], v[164:167]
    ds_read_b128 v[128:131], v1 offset:3680
    v_mfma_f32_16x16x32_bf16 v[168:171], v[40:43], v[72:75], 0
    ds_read_b128 v[132:135], v1 offset:3616
    v_mfma_f32_16x16x32_bf16 v[168:171], v[44:47], v[76:79], v[168:171]
    v_mfma_f32_16x16x32_bf16 v[168:171], v[48:51], v[80:83], v[168:171]
    v_mfma_f32_16x16x32_bf16 v[168:171], v[52:55], v[84:87], v[168:171]
    s_waitcnt lgkmcnt(3)
    s_nop 0
    v_add_f32 v164, v164, v136
    v_add_f32 v165, v165, v137
    v_add_f32 v166, v166, v138
    v_add_f32 v167, v167, v139
    v_cvt_pk_bf16_f32 v6, v164, v165
    v_cvt_pk_bf16_f32 v7, v166, v167
    ds_write2st64_b32 v2, v6, v7 offset0:43 offset1:44
    ds_add_u32 v208, v5 offset:1536
    v_mfma_f32_16x16x32_bf16 v[168:171], v[56:59], v[88:91], v[168:171]
    v_mfma_f32_16x16x32_bf16 v[168:171], v[8:11], v[104:107], v[168:171]
    ds_read_b32 v224, v225 offset:1792
    v_mfma_f32_16x16x32_bf16 v[168:171], v[12:15], v[108:111], v[168:171]
    v_mfma_f32_16x16x32_bf16 v[168:171], v[16:19], v[112:115], v[168:171]
    v_mfma_f32_16x16x32_bf16 v[168:171], v[20:23], v[116:119], v[168:171]
    v_mfma_f32_16x16x32_bf16 v[168:171], v[24:27], v[120:123], v[168:171]
    s_waitcnt lgkmcnt(3)
    v_mfma_f32_16x16x32_bf16 v[168:171], v[28:31], v[124:127], v[168:171]
    s_waitcnt lgkmcnt(0)
    v_readfirstlane_b32 s33, v224
    s_cmp_lt_u32 s33, 1
    s_cbranch_scc1 L_pn7
L_pn7_e:
    ds_read_b128 v[136:139], v206 offset:5120
    v_mfma_f32_16x16x32_bf16 v[168:171], v[32:35], v[128:131], v[168:171]
    v_mfma_f32_16x16x32_bf16 v[168:171], v[36:39], v[132:135], v[168:171]
    s_waitcnt lgkmcnt(0)
    s_nop 6
    v_add_f32 v168, v168, v136
    v_add_f32 v169, v169, v137
    v_add_f32 v170, v170, v138
    v_add_f32 v171, v171, v139
    v_cvt_pk_bf16_f32 v6, v168, v169
    v_cvt_pk_bf16_f32 v7, v170, v171
    ds_write2st64_b32 v2, v6, v7 offset0:45 offset1:46
    ds_add_u32 v208, v5 offset:1792
    s_cmp_lg_u32 s59, 0
    s_cbranch_scc1 L_fd4
    ds_read_b32 v224, v226 offset:1024
    s_waitcnt lgkmcnt(0)
    v_readfirstlane_b32 s33, v224
    s_cmp_lt_u32 s33, 6
    s_cbranch_scc1 L_fp4
L_fp4_e:
    ds_read_b32 v212, v3 offset:2048
    ds_read_b32 v213, v3 offset:2304
    ds_read_b32 v214, v3 offset:17280
    ds_read_b32 v215, v3 offset:17536
    ds_read_b32 v216, v3 offset:32512
    ds_read_b32 v217, v3 offset:32768
    ds_read_b32 v218, v3 offset:47744
    ds_read_b32 v219, v3 offset:48000
    ds_read_b32 v220, v211 offset:2048
    ds_read_b32 v221, v211 offset:2304
    ds_read_b32 v222, v211 offset:32512
    ds_read_b32 v223, v211 offset:32768
    s_add_u32 s50, s24, 2359296
    s_addc_u32 s51, s25, 0
    s_waitcnt lgkmcnt(0)
    v_perm_b32 v172, v214, v212, s40
    v_perm_b32 v173, v218, v216, s40
    v_perm_b32 v174, v222, v220, s40
    global_store_dwordx3 v179, v[172:174], s[50:51] offset:-3456
    v_perm_b32 v176, v214, v212, s41
    v_perm_b32 v177, v218, v216, s41
    v_perm_b32 v178, v222, v220, s41
    global_store_dwordx3 v179, v[176:178], s[50:51] offset:-1152
    v_perm_b32 v180, v215, v213, s40
    v_perm_b32 v181, v219, v217, s40
    v_perm_b32 v182, v223, v221, s40
    global_store_dwordx3 v179, v[180:182], s[50:51] offset:1152
    v_perm_b32 v184, v215, v213, s41
    v_perm_b32 v185, v219, v217, s41
    v_perm_b32 v186, v223, v221, s41
    global_store_dwordx3 v179, v[184:186], s[50:51] offset:3456
L_fd4:
    s_cmp_lg_u32 s59, 1
    s_cbranch_scc1 L_fd6
    ds_read_b32 v224, v226 offset:1536
    s_waitcnt lgkmcnt(0)
    v_readfirstlane_b32 s33, v224
    s_cmp_lt_u32 s33, 6
    s_cbranch_scc1 L_fp6
L_fp6_e:
    ds_read_b32 v212, v3 offset:3072
    ds_read_b32 v213, v3 offset:3328
    ds_read_b32 v214, v3 offset:18304
    ds_read_b32 v215, v3 offset:18560
    ds_read_b32 v216, v3 offset:33536
    ds_read_b32 v217, v3 offset:33792
    ds_read_b32 v218, v3 offset:48768
    ds_read_b32 v219, v3 offset:49024
    ds_read_b32 v220, v211 offset:3072
    ds_read_b32 v221, v211 offset:3328
    ds_read_b32 v222, v211 offset:33536
    ds_read_b32 v223, v211 offset:33792
    s_add_u32 s50, s24, 3538944
    s_addc_u32 s51, s25, 0
    s_waitcnt lgkmcnt(0)
    v_perm_b32 v172, v214, v212, s40
    v_perm_b32 v173, v218, v216, s40
    v_perm_b32 v174, v222, v220, s40
    global_store_dwordx3 v179, v[172:174], s[50:51] offset:-3456
    v_perm_b32 v176, v214, v212, s41
    v_perm_b32 v177, v218, v216, s41
    v_perm_b32 v178, v222, v220, s41
    global_store_dwordx3 v179, v[176:178], s[50:51] offset:-1152
    v_perm_b32 v180, v215, v213, s40
    v_perm_b32 v181, v219, v217, s40
    v_perm_b32 v182, v223, v221, s40
    global_store_dwordx3 v179, v[180:182], s[50:51] offset:1152
    v_perm_b32 v184, v215, v213, s41
    v_perm_b32 v185, v219, v217, s41
    v_perm_b32 v186, v223, v221, s41
    global_store_dwordx3 v179, v[184:186], s[50:51] offset:3456
L_fd6:
    ds_read_b32 v224, v226 offset:1792
    s_waitcnt lgkmcnt(0)
    v_readfirstlane_b32 s33, v224
    s_cmp_lt_u32 s33, 6
    s_cbranch_scc1 L_wn8
L_wn8_e:
    ds_read_b32 v172, v3 offset:3584
    ds_read_b32 v173, v3 offset:18816
    ds_read_b32 v174, v3 offset:34048
    ds_read_b32 v175, v3 offset:49280
    ds_read_b32 v176, v211 offset:3584
    ds_read_b32 v177, v211 offset:34048
    s_waitcnt lgkmcnt(0)
    v_perm_b32 v172, v173, v172, s58
    v_perm_b32 v173, v175, v174, s58
    v_perm_b32 v174, v177, v176, s58
    global_store_dwordx3 v4, v[172:174], s[24:25]
    s_branch L_fin
L_polln:
    ds_read_b32 v224, v210 offset:0
    s_waitcnt lgkmcnt(0)
    v_readfirstlane_b32 s33, v224
    s_cmp_lt_u32 s33, 4
    s_cbranch_scc0 L_polln_e
    s_sub_u32 s53, s53, 1
    s_cbranch_scc0 L_polln
    s_endpgm
L_fp0:
    ds_read_b32 v224, v226 offset:0
    s_waitcnt lgkmcnt(0)
    v_readfirstlane_b32 s33, v224
    s_cmp_lt_u32 s33, 6
    s_cbranch_scc0 L_fp0_e
    s_sub_u32 s53, s53, 1
    s_cbranch_scc0 L_fp0
    s_endpgm
L_pn2:
    ds_read_b32 v224, v225 offset:512
    s_waitcnt lgkmcnt(0)
    v_readfirstlane_b32 s33, v224
    s_cmp_lt_u32 s33, 1
    s_cbranch_scc0 L_pn2_e
    s_sub_u32 s53, s53, 1
    s_cbranch_scc0 L_pn2
    s_endpgm
L_un:
    ds_read_b32 v224, v210 offset:4
    s_waitcnt lgkmcnt(0)
    v_readfirstlane_b32 s33, v224
    s_cmp_lt_u32 s33, 4
    s_cbranch_scc0 L_un_e
    s_sub_u32 s53, s53, 1
    s_cbranch_scc0 L_un
    s_endpgm
L_pn3:
    ds_read_b32 v224, v225 offset:768
    s_waitcnt lgkmcnt(0)
    v_readfirstlane_b32 s33, v224
    s_cmp_lt_u32 s33, 1
    s_cbranch_scc0 L_pn3_e
    s_sub_u32 s53, s53, 1
    s_cbranch_scc0 L_pn3
    s_endpgm
L_fp2:
    ds_read_b32 v224, v226 offset:512
    s_waitcnt lgkmcnt(0)
    v_readfirstlane_b32 s33, v224
    s_cmp_lt_u32 s33, 6
    s_cbranch_scc0 L_fp2_e
    s_sub_u32 s53, s53, 1
    s_cbranch_scc0 L_fp2
    s_endpgm
L_pn4:
    ds_read_b32 v224, v225 offset:1024
    s_waitcnt lgkmcnt(0)
    v_readfirstlane_b32 s33, v224
    s_cmp_lt_u32 s33, 1
    s_cbranch_scc0 L_pn4_e
    s_sub_u32 s53, s53, 1
    s_cbranch_scc0 L_pn4
    s_endpgm
L_pn5:
    ds_read_b32 v224, v225 offset:1280
    s_waitcnt lgkmcnt(0)
    v_readfirstlane_b32 s33, v224
    s_cmp_lt_u32 s33, 1
    s_cbranch_scc0 L_pn5_e
    s_sub_u32 s53, s53, 1
    s_cbranch_scc0 L_pn5
    s_endpgm
L_pn6:
    ds_read_b32 v224, v225 offset:1536
    s_waitcnt lgkmcnt(0)
    v_readfirstlane_b32 s33, v224
    s_cmp_lt_u32 s33, 1
    s_cbranch_scc0 L_pn6_e
    s_sub_u32 s53, s53, 1
    s_cbranch_scc0 L_pn6
    s_endpgm
L_pn7:
    ds_read_b32 v224, v225 offset:1792
    s_waitcnt lgkmcnt(0)
    v_readfirstlane_b32 s33, v224
    s_cmp_lt_u32 s33, 1
    s_cbranch_scc0 L_pn7_e
    s_sub_u32 s53, s53, 1
    s_cbranch_scc0 L_pn7
    s_endpgm
L_fp4:
    ds_read_b32 v224, v226 offset:1024
    s_waitcnt lgkmcnt(0)
    v_readfirstlane_b32 s33, v224
    s_cmp_lt_u32 s33, 6
    s_cbranch_scc0 L_fp4_e
    s_sub_u32 s53, s53, 1
    s_cbranch_scc0 L_fp4
    s_endpgm
L_fp6:
    ds_read_b32 v224, v226 offset:1536
    s_waitcnt lgkmcnt(0)
    v_readfirstlane_b32 s33, v224
    s_cmp_lt_u32 s33, 6
    s_cbranch_scc0 L_fp6_e
    s_sub_u32 s53, s53, 1
    s_cbranch_scc0 L_fp6
    s_endpgm
L_wn8:
    ds_read_b32 v224, v226 offset:1792
    s_waitcnt lgkmcnt(0)
    v_readfirstlane_b32 s33, v224
    s_cmp_lt_u32 s33, 6
    s_cbranch_scc0 L_wn8_e
    s_sub_u32 s53, s53, 1
    s_cbranch_scc0 L_wn8
    s_endpgm
L_far:
    v_mov_b32 v2, v165
    v_cvt_pk_bf16_f32 v165, v150, v151
    ds_read_b32 v206, v210
    v_cmp_eq_u32 vcc, s59, v204
    s_add_u32 s33, s29, 8192
    v_add_u32 v5, s33, v5
    v_mov_b32 v205, 157704
    v_cndmask_b32 v6, 0, 1, vcc
    v_readlane_b32 s45, v166, 63
    v_readlane_b32 s46, v167, 63
    ds_write_b32 v233, v164 offset:8
    ds_write_b32 v233, v164 offset:640
    ds_write_b16 v234, v165 offset:76
    ds_write_b16_d16_hi v234, v165 offset:12
    ds_write_b16 v234, v165 offset:520
    ds_write_b16_d16_hi v234, v165 offset:456
    ds_write_b16 v234, v165 offset:964
    ds_write_b16_d16_hi v234, v165 offset:900
    ds_write_b16 v234, v165 offset:1408
    ds_write_b16_d16_hi v234, v165 offset:1344
    s_waitcnt lgkmcnt(10)
    v_readfirstlane_b32 s33, v206
    s_cmp_lt_u32 s33, 4
    s_cbranch_scc1 L_pollf
L_pollf_e:
    ds_read_b128 v[8:11], v1 offset:480
    ds_read_b128 v[12:15], v1 offset:464
    ds_read_b128 v[80:83], v238 offset:256
    ds_read_b128 v[84:87], v238 offset:272
    ds_read_b128 v[88:91], v238 offset:128
    ds_read_b128 v[92:95], v238 offset:144
    ds_read_b128 v[96:99], v238 offset:0
    ds_read_b128 v[100:103], v238 offset:16
    ds_read_b128 v[104:107], v239 offset:192
    ds_read_b128 v[108:111], v239 offset:128
    ds_read_b128 v[112:115], v239 offset:64
    ds_read_b128 v[116:119], v239 offset:0
    v_and_b32 v76, s46, v248
    v_and_b32 v77, s46, v249
    v_and_b32 v78, s46, v250
    v_and_b32 v79, s46, v251
    s_waitcnt lgkmcnt(10)
    v_mfma_f32_16x16x32_bf16 v[212:215], v[12:15], v[120:123], 0
    v_mfma_f32_16x16x32_bf16 v[216:219], v[8:11], v[124:127], 0
    v_mfma_f32_16x16x32_bf16 v[220:223], v[8:11], v[120:123], 0
    v_mfma_f32_16x16x32_bf16 v[224:227], v[8:11], v[128:131], 0
    v_mfma_f32_16x16x32_bf16 v[180:183], v[12:15], v[132:135], 0
    v_mfma_f32_16x16x32_bf16 v[184:187], v[8:11], v[136:139], 0
    ds_read_b128 v[16:19], v1 offset:992
    ds_read_b128 v[20:23], v1 offset:976
    ds_read_b128 v[144:147], v1 offset:672
    ds_read_b128 v[56:59], v1 offset:608
    ds_read_b128 v[60:63], v1 offset:544
    v_cvt_pk_bf16_f32 v228, v212, v216
    v_cvt_pk_bf16_f32 v229, v220, v224
    v_cvt_pk_bf16_f32 v230, v213, v217
    v_cvt_pk_bf16_f32 v231, v221, v225
    s_waitcnt lgkmcnt(14)
    s_nop 0
    v_mfma_f32_16x16x32_bf16 v[148:151], v[228:231], v[80:83], 0
    v_cvt_pk_bf16_f32 v232, v214, v218
    v_cvt_pk_bf16_f32 v233, v222, v226
    s_waitcnt lgkmcnt(5)
    v_mfma_f32_16x16x32_bf16 v[152:155], v[228:231], v[88:91], 0
    v_cvt_pk_bf16_f32 v234, v215, v219
    v_cvt_pk_bf16_f32 v235, v223, v227
    v_mfma_f32_16x16x32_bf16 v[156:159], v[228:231], v[96:99], 0
    v_cvt_pk_bf16_f32 v240, v180, v184
    v_cvt_pk_bf16_f32 v241, v181, v185
    v_mfma_f32_16x16x32_bf16 v[148:151], v[232:235], v[84:87], v[148:151]
    v_cvt_pk_bf16_f32 v242, v182, v186
    v_cvt_pk_bf16_f32 v243, v183, v187
    v_mfma_f32_16x16x32_bf16 v[152:155], v[232:235], v[92:95], v[152:155]
    v_mfma_f32_16x16x32_bf16 v[156:159], v[232:235], v[100:103], v[156:159]
    v_mfma_f32_16x16x32_bf16 v[156:159], v[240:243], v[104:107], v[156:159]
    v_mfma_f32_16x16x32_bf16 v[160:163], v[240:243], v[108:111], 0
    s_waitcnt lgkmcnt(0)
    v_mfma_f32_16x16x32_bf16 v[212:215], v[20:23], v[120:123], 0
    v_mfma_f32_16x16x32_bf16 v[216:219], v[16:19], v[124:127], 0
    v_mfma_f32_16x16x32_bf16 v[220:223], v[16:19], v[120:123], 0
    v_mfma_f32_16x16x32_bf16 v[224:227], v[16:19], v[128:131], 0
    ds_read_b32 v204, v205 offset:0
    s_waitcnt lgkmcnt(0)
    v_readfirstlane_b32 s33, v204
    s_cmp_lt_u32 s33, 6
    s_cbranch_scc1 L_wf1
L_wf1_e:
    s_setprio 2
    ds_read_b64 v[140:141], v237 offset:192
    ds_read_b64 v[142:143], v237 offset:200
    ds_read_b64 v[64:65], v237 offset:128
    ds_read_b64 v[66:67], v237 offset:136
    ds_read_b64 v[68:69], v237 offset:64
    ds_read_b64 v[70:71], v237 offset:72
    ds_read_b64 v[72:73], v237 offset:0
    ds_read_b64 v[74:75], v237 offset:8
    v_add_u32 v236, -256, v3
    v_add_u32 v238, -256, v211
    s_waitcnt lgkmcnt(0)
    v_and_or_b32 v72, s45, v244, v72
    v_and_or_b32 v73, s45, v245, v73
    v_and_or_b32 v74, s45, v246, v74
    v_and_or_b32 v75, s45, v247, v75
    s_nop 1
    v_mfma_f32_16x16x32_bf16 v[148:151], v[72:75], v[8:11], v[148:151]
    v_mfma_f32_16x16x32_bf16 v[148:151], v[140:143], v[144:147], v[148:151]
    v_mfma_f32_16x16x32_bf16 v[148:151], v[64:67], v[56:59], v[148:151]
    v_mfma_f32_16x16x32_bf16 v[148:151], v[68:71], v[60:63], v[148:151]
    ds_read_b128 v[144:147], v1 offset:1184
    ds_read_b128 v[56:59], v1 offset:1120
    ds_read_b128 v[60:63], v1 offset:1056
    ds_read_b128 v[24:27], v1 offset:1504
    ds_read_b128 v[28:31], v1 offset:1488
    v_mfma_f32_16x16x32_bf16 v[152:155], v[72:75], v[16:19], v[152:155]
    s_nop 1
    ds_write_b128 v5, v[148:151] offset:0
    ds_add_u32 v208, v6 offset:512
    v_cvt_pk_bf16_f32 v228, v212, v216
    v_cvt_pk_bf16_f32 v229, v220, v224
    v_cvt_pk_bf16_f32 v230, v213, v217
    v_cvt_pk_bf16_f32 v231, v221, v225
    s_nop 1
    v_mfma_f32_16x16x32_bf16 v[152:155], v[228:231], v[80:83], v[152:155]
    v_cvt_pk_bf16_f32 v232, v214, v218
    v_cvt_pk_bf16_f32 v233, v222, v226
    v_mfma_f32_16x16x32_bf16 v[156:159], v[228:231], v[88:91], v[156:159]
    v_cvt_pk_bf16_f32 v234, v215, v219
    v_cvt_pk_bf16_f32 v235, v223, v227
    v_mfma_f32_16x16x32_bf16 v[160:163], v[228:231], v[96:99], v[160:163]
    s_nop 0
    v_mfma_f32_16x16x32_bf16 v[152:155], v[232:235], v[84:87], v[152:155]
    v_mfma_f32_16x16x32_bf16 v[156:159], v[232:235], v[92:95], v[156:159]
    v_mfma_f32_16x16x32_bf16 v[160:163], v[232:235], v[100:103], v[160:163]
    v_mfma_f32_16x16x32_bf16 v[156:159], v[76:79], v[8:11], v[156:159]
    s_setprio 0
    s_waitcnt vmcnt(0)
    v_perm_b32 v212, v192, v188, s40
    v_perm_b32 v213, v200, v196, s40
    ds_write_b64 v253, v[212:213] offset:2048
    v_perm_b32 v214, v192, v188, s41
    v_perm_b32 v215, v200, v196, s41
    ds_write_b64 v253, v[214:215] offset:6656
    v_perm_b32 v216, v193, v189, s40
    v_perm_b32 v217, v201, v197, s40
    ds_write_b64 v253, v[216:217] offset:11264
    v_perm_b32 v218, v193, v189, s41
    v_perm_b32 v219, v201, v197, s41
    ds_write_b64 v253, v[218:219] offset:15872
    v_perm_b32 v220, v194, v190, s40
    v_perm_b32 v221, v202, v198, s40
    ds_write_b64 v253, v[220:221] offset:20480
    v_perm_b32 v222, v194, v190, s41
    v_perm_b32 v223, v202, v198, s41
    ds_write_b64 v253, v[222:223] offset:25088
    ds_add_u32 v208, v2 offset:2052
    s_setprio 2
    s_waitcnt lgkmcnt(7)
    v_mfma_f32_16x16x32_bf16 v[152:155], v[140:143], v[144:147], v[152:155]
    v_mfma_f32_16x16x32_bf16 v[152:155], v[64:67], v[56:59], v[152:155]
    v_mfma_f32_16x16x32_bf16 v[152:155], v[68:71], v[60:63], v[152:155]
    ds_read_b128 v[144:147], v1 offset:1696
    ds_read_b128 v[56:59], v1 offset:1632
    ds_read_b128 v[60:63], v1 offset:1568
    v_mfma_f32_16x16x32_bf16 v[212:215], v[28:31], v[120:123], 0
    v_mfma_f32_16x16x32_bf16 v[216:219], v[24:27], v[124:127], 0
    v_mfma_f32_16x16x32_bf16 v[220:223], v[24:27], v[120:123], 0
    v_mfma_f32_16x16x32_bf16 v[224:227], v[24:27], v[128:131], 0
    v_mfma_f32_16x16x32_bf16 v[180:183], v[20:23], v[132:135], 0
    v_mfma_f32_16x16x32_bf16 v[184:187], v[16:19], v[136:139], 0
    ds_read_b128 v[32:35], v1 offset:2016
    ds_read_b128 v[36:39], v1 offset:2000
    v_mfma_f32_16x16x32_bf16 v[156:159], v[72:75], v[24:27], v[156:159]
    ds_write_b128 v5, v[152:155] offset:1024
    ds_add_u32 v208, v6 offset:768
    v_cvt_pk_bf16_f32 v228, v212, v216
    v_cvt_pk_bf16_f32 v229, v220, v224
    v_cvt_pk_bf16_f32 v230, v213, v217
    v_cvt_pk_bf16_f32 v231, v221, v225
    s_nop 1
    v_mfma_f32_16x16x32_bf16 v[156:159], v[228:231], v[80:83], v[156:159]
    v_cvt_pk_bf16_f32 v232, v214, v218
    v_cvt_pk_bf16_f32 v233, v222, v226
    v_mfma_f32_16x16x32_bf16 v[160:163], v[228:231], v[88:91], v[160:163]
    v_cvt_pk_bf16_f32 v234, v215, v219
    v_cvt_pk_bf16_f32 v235, v223, v227
    v_mfma_f32_16x16x32_bf16 v[164:167], v[228:231], v[96:99], 0
    v_cvt_pk_bf16_f32 v244, v180, v184
    v_cvt_pk_bf16_f32 v245, v181, v185
    v_mfma_f32_16x16x32_bf16 v[156:159], v[232:235], v[84:87], v[156:159]
    v_cvt_pk_bf16_f32 v246, v182, v186
    v_cvt_pk_bf16_f32 v247, v183, v187
    v_mfma_f32_16x16x32_bf16 v[160:163], v[232:235], v[92:95], v[160:163]
    v_mfma_f32_16x16x32_bf16 v[164:167], v[232:235], v[100:103], v[164:167]
    s_cmp_lg_u32 s59, 0
    s_cbranch_scc1 L_fd1
    ds_read_b32 v204, v205 offset:256
    s_waitcnt lgkmcnt(0)
    v_readfirstlane_b32 s33, v204
    s_cmp_lt_u32 s33, 6
    s_cbranch_scc1 L_fp1
L_fp1_e:
    s_setprio 2
    ds_read_b32 v188, v236 offset:512
    ds_read_b32 v189, v236 offset:768
    ds_read_b32 v190, v236 offset:15744
    ds_read_b32 v191, v236 offset:16000
    ds_read_b32 v192, v236 offset:30976
    ds_read_b32 v193, v236 offset:31232
    ds_read_b32 v194, v236 offset:46208
    ds_read_b32 v195, v236 offset:46464
    ds_read_b32 v172, v238 offset:512
    ds_read_b32 v173, v238 offset:768
    ds_read_b32 v174, v238 offset:30976
    ds_read_b32 v175, v238 offset:31232
    s_add_u32 s50, s24, 589824
    s_addc_u32 s51, s25, 0
    s_waitcnt lgkmcnt(0)
    v_perm_b32 v196, v190, v188, s40
    v_perm_b32 v197, v194, v192, s40
    v_perm_b32 v198, v174, v172, s40
    global_store_dwordx3 v179, v[196:198], s[50:51] offset:-3456
    v_perm_b32 v200, v190, v188, s41
    v_perm_b32 v201, v194, v192, s41
    v_perm_b32 v202, v174, v172, s41
    global_store_dwordx3 v179, v[200:202], s[50:51] offset:-1152
    v_perm_b32 v176, v191, v189, s40
    v_perm_b32 v177, v195, v193, s40
    v_perm_b32 v178, v175, v173, s40
    global_store_dwordx3 v179, v[176:178], s[50:51] offset:1152
    v_perm_b32 v188, v191, v189, s41
    v_perm_b32 v189, v195, v193, s41
    v_perm_b32 v190, v175, v173, s41
    global_store_dwordx3 v179, v[188:190], s[50:51] offset:3456
L_fd1:
    s_waitcnt lgkmcnt(2)
    v_mfma_f32_16x16x32_bf16 v[156:159], v[140:143], v[144:147], v[156:159]
    v_mfma_f32_16x16x32_bf16 v[156:159], v[64:67], v[56:59], v[156:159]
    v_mfma_f32_16x16x32_bf16 v[156:159], v[68:71], v[60:63], v[156:159]
    ds_read_b32 v204, v210 offset:4
    s_waitcnt lgkmcnt(0)
    v_readfirstlane_b32 s33, v204
    s_cmp_lt_u32 s33, 4
    s_cbranch_scc1 L_uf
L_uf_e:
    ds_read_b128 v[144:147], v1 offset:2208
    ds_read_b128 v[56:59], v1 offset:2144
    ds_read_b128 v[60:63], v1 offset:2080
    v_mfma_f32_16x16x32_bf16 v[212:215], v[36:39], v[120:123], 0
    v_mfma_f32_16x16x32_bf16 v[216:219], v[32:35], v[124:127], 0
    v_mfma_f32_16x16x32_bf16 v[220:223], v[32:35], v[120:123], 0
    v_mfma_f32_16x16x32_bf16 v[224:227], v[32:35], v[128:131], 0
    ds_read_b128 v[40:43], v1 offset:2528
    ds_read_b128 v[44:47], v1 offset:2512
    v_mfma_f32_16x16x32_bf16 v[160:163], v[72:75], v[32:35], v[160:163]
    ds_write_b128 v5, v[156:159] offset:2048
    ds_add_u32 v208, v6 offset:1024
    s_nop 0
    v_cvt_pk_bf16_f32 v228, v212, v216
    s_nop 0
    v_cvt_pk_bf16_f32 v229, v220, v224
    v_cvt_pk_bf16_f32 v230, v213, v217
    v_cvt_pk_bf16_f32 v231, v221, v225
    s_nop 1
    v_mfma_f32_16x16x32_bf16 v[160:163], v[228:231], v[80:83], v[160:163]
    v_cvt_pk_bf16_f32 v232, v214, v218
    v_cvt_pk_bf16_f32 v233, v222, v226
    v_mfma_f32_16x16x32_bf16 v[164:167], v[228:231], v[88:91], v[164:167]
    v_cvt_pk_bf16_f32 v234, v215, v219
    v_cvt_pk_bf16_f32 v235, v223, v227
    v_mfma_f32_16x16x32_bf16 v[168:171], v[228:231], v[96:99], 0
    s_nop 0
    v_mfma_f32_16x16x32_bf16 v[160:163], v[232:235], v[84:87], v[160:163]
    v_mfma_f32_16x16x32_bf16 v[164:167], v[232:235], v[92:95], v[164:167]
    v_mfma_f32_16x16x32_bf16 v[168:171], v[232:235], v[100:103], v[168:171]
    v_mfma_f32_16x16x32_bf16 v[160:163], v[244:247], v[104:107], v[160:163]
    v_mfma_f32_16x16x32_bf16 v[160:163], v[76:79], v[16:19], v[160:163]
    s_waitcnt lgkmcnt(0)
    v_mfma_f32_16x16x32_bf16 v[160:163], v[140:143], v[144:147], v[160:163]
    v_mfma_f32_16x16x32_bf16 v[160:163], v[64:67], v[56:59], v[160:163]
    v_mfma_f32_16x16x32_bf16 v[160:163], v[68:71], v[60:63], v[160:163]
    ds_read_b128 v[144:147], v1 offset:2720
    ds_read_b128 v[56:59], v1 offset:2656
    ds_read_b128 v[60:63], v1 offset:2592
    v_mfma_f32_16x16x32_bf16 v[212:215], v[44:47], v[120:123], 0
    v_mfma_f32_16x16x32_bf16 v[216:219], v[40:43], v[124:127], 0
    v_mfma_f32_16x16x32_bf16 v[220:223], v[40:43], v[120:123], 0
    v_mfma_f32_16x16x32_bf16 v[224:227], v[40:43], v[128:131], 0
    v_mfma_f32_16x16x32_bf16 v[180:183], v[28:31], v[132:135], 0
    v_mfma_f32_16x16x32_bf16 v[184:187], v[24:27], v[136:139], 0
    ds_read_b128 v[48:51], v1 offset:3040
    ds_read_b128 v[52:55], v1 offset:3024
    v_mfma_f32_16x16x32_bf16 v[164:167], v[72:75], v[40:43], v[164:167]
    ds_write_b128 v5, v[160:163] offset:3072
    ds_add_u32 v208, v6 offset:1280
    v_cvt_pk_bf16_f32 v228, v212, v216
    v_cvt_pk_bf16_f32 v229, v220, v224
    v_cvt_pk_bf16_f32 v230, v213, v217
    v_cvt_pk_bf16_f32 v231, v221, v225
    s_nop 1
    v_mfma_f32_16x16x32_bf16 v[164:167], v[228:231], v[80:83], v[164:167]
    v_cvt_pk_bf16_f32 v232, v214, v218
    v_cvt_pk_bf16_f32 v233, v222, v226
    v_mfma_f32_16x16x32_bf16 v[168:171], v[228:231], v[88:91], v[168:171]
    v_cvt_pk_bf16_f32 v234, v215, v219
    v_cvt_pk_bf16_f32 v235, v223, v227
    s_nop 1
    v_mfma_f32_16x16x32_bf16 v[164:167], v[232:235], v[84:87], v[164:167]
    v_cvt_pk_bf16_f32 v248, v180, v184
    v_cvt_pk_bf16_f32 v249, v181, v185
    v_mfma_f32_16x16x32_bf16 v[168:171], v[232:235], v[92:95], v[168:171]
    v_cvt_pk_bf16_f32 v250, v182, v186
    v_cvt_pk_bf16_f32 v251, v183, v187
    v_mfma_f32_16x16x32_bf16 v[164:167], v[240:243], v[112:115], v[164:167]
    v_mfma_f32_16x16x32_bf16 v[164:167], v[244:247], v[108:111], v[164:167]
    v_mfma_f32_16x16x32_bf16 v[164:167], v[248:251], v[104:107], v[164:167]
    v_mfma_f32_16x16x32_bf16 v[164:167], v[76:79], v[24:27], v[164:167]
    s_waitcnt lgkmcnt(0)
    v_mfma_f32_16x16x32_bf16 v[164:167], v[140:143], v[144:147], v[164:167]
    v_mfma_f32_16x16x32_bf16 v[164:167], v[64:67], v[56:59], v[164:167]
    v_mfma_f32_16x16x32_bf16 v[164:167], v[68:71], v[60:63], v[164:167]
    ds_read_b128 v[144:147], v1 offset:3232
    ds_read_b128 v[56:59], v1 offset:3168
    ds_read_b128 v[60:63], v1 offset:3104
    v_mfma_f32_16x16x32_bf16 v[212:215], v[52:55], v[120:123], 0
    v_mfma_f32_16x16x32_bf16 v[216:219], v[48:51], v[124:127], 0
    v_mfma_f32_16x16x32_bf16 v[220:223], v[48:51], v[120:123], 0
    v_mfma_f32_16x16x32_bf16 v[224:227], v[48:51], v[128:131], 0
    v_mfma_f32_16x16x32_bf16 v[180:183], v[36:39], v[132:135], 0
    v_mfma_f32_16x16x32_bf16 v[184:187], v[32:35], v[136:139], 0
    v_mfma_f32_16x16x32_bf16 v[168:171], v[72:75], v[48:51], v[168:171]
    ds_write_b128 v5, v[164:167] offset:4096
    ds_add_u32 v208, v6 offset:1536
    s_nop 0
    v_cvt_pk_bf16_f32 v228, v212, v216
    s_nop 0
    v_cvt_pk_bf16_f32 v229, v220, v224
    v_cvt_pk_bf16_f32 v230, v213, v217
    v_cvt_pk_bf16_f32 v231, v221, v225
    s_nop 1
    v_mfma_f32_16x16x32_bf16 v[168:171], v[228:231], v[80:83], v[168:171]
    v_cvt_pk_bf16_f32 v232, v214, v218
    v_cvt_pk_bf16_f32 v233, v222, v226
    v_cvt_pk_bf16_f32 v234, v215, v219
    v_cvt_pk_bf16_f32 v235, v223, v227
    s_nop 1
    v_mfma_f32_16x16x32_bf16 v[168:171], v[232:235], v[84:87], v[168:171]
    v_cvt_pk_bf16_f32 v252, v180, v184
    v_cvt_pk_bf16_f32 v253, v181, v185
    v_cvt_pk_bf16_f32 v254, v182, v186
    v_cvt_pk_bf16_f32 v255, v183, v187
    v_mfma_f32_16x16x32_bf16 v[168:171], v[240:243], v[116:119], v[168:171]
    v_mfma_f32_16x16x32_bf16 v[168:171], v[244:247], v[112:115], v[168:171]
    v_mfma_f32_16x16x32_bf16 v[168:171], v[248:251], v[108:111], v[168:171]
    v_mfma_f32_16x16x32_bf16 v[168:171], v[252:255], v[104:107], v[168:171]
    v_mfma_f32_16x16x32_bf16 v[168:171], v[76:79], v[32:35], v[168:171]
    s_waitcnt lgkmcnt(0)
    v_mfma_f32_16x16x32_bf16 v[168:171], v[140:143], v[144:147], v[168:171]
    v_mfma_f32_16x16x32_bf16 v[168:171], v[64:67], v[56:59], v[168:171]
    v_mfma_f32_16x16x32_bf16 v[168:171], v[68:71], v[60:63], v[168:171]
    s_nop 7
    ds_write_b128 v5, v[168:171] offset:5120
    ds_add_u32 v208, v6 offset:1792
    s_cmp_lg_u32 s59, 1
    s_cbranch_scc1 L_fd3
    ds_read_b32 v204, v205 offset:768
    s_waitcnt lgkmcnt(0)
    v_readfirstlane_b32 s33, v204
    s_cmp_lt_u32 s33, 6
    s_cbranch_scc1 L_fp3
L_fp3_e:
    ds_read_b32 v188, v236 offset:1536
    ds_read_b32 v189, v236 offset:1792
    ds_read_b32 v190, v236 offset:16768
    ds_read_b32 v191, v236 offset:17024
    ds_read_b32 v192, v236 offset:32000
    ds_read_b32 v193, v236 offset:32256
    ds_read_b32 v194, v236 offset:47232
    ds_read_b32 v195, v236 offset:47488
    ds_read_b32 v172, v238 offset:1536
    ds_read_b32 v173, v238 offset:1792
    ds_read_b32 v174, v238 offset:32000
    ds_read_b32 v175, v238 offset:32256
    s_add_u32 s50, s24, 1769472
    s_addc_u32 s51, s25, 0
    s_waitcnt lgkmcnt(0)
    v_perm_b32 v196, v190, v188, s40
    v_perm_b32 v197, v194, v192, s40
    v_perm_b32 v198, v174, v172, s40
    global_store_dwordx3 v179, v[196:198], s[50:51] offset:-3456
    v_perm_b32 v200, v190, v188, s41
    v_perm_b32 v201, v194, v192, s41
    v_perm_b32 v202, v174, v172, s41
    global_store_dwordx3 v179, v[200:202], s[50:51] offset:-1152
    v_perm_b32 v176, v191, v189, s40
    v_perm_b32 v177, v195, v193, s40
    v_perm_b32 v178, v175, v173, s40
    global_store_dwordx3 v179, v[176:178], s[50:51] offset:1152
    v_perm_b32 v188, v191, v189, s41
    v_perm_b32 v189, v195, v193, s41
    v_perm_b32 v190, v175, v173, s41
    global_store_dwordx3 v179, v[188:190], s[50:51] offset:3456
L_fd3:
    s_cmp_lg_u32 s59, 0
    s_cbranch_scc1 L_fd5
    ds_read_b32 v204, v205 offset:1280
    s_waitcnt lgkmcnt(0)
    v_readfirstlane_b32 s33, v204
    s_cmp_lt_u32 s33, 6
    s_cbranch_scc1 L_fp5
L_fp5_e:
    ds_read_b32 v188, v236 offset:2560
    ds_read_b32 v189, v236 offset:2816
    ds_read_b32 v190, v236 offset:17792
    ds_read_b32 v191, v236 offset:18048
    ds_read_b32 v192, v236 offset:33024
    ds_read_b32 v193, v236 offset:33280
    ds_read_b32 v194, v236 offset:48256
    ds_read_b32 v195, v236 offset:48512
    ds_read_b32 v172, v238 offset:2560
    ds_read_b32 v173, v238 offset:2816
    ds_read_b32 v174, v238 offset:33024
    ds_read_b32 v175, v238 offset:33280
    s_add_u32 s50, s24, 2949120
    s_addc_u32 s51, s25, 0
    s_waitcnt lgkmcnt(0)
    v_perm_b32 v196, v190, v188, s40
    v_perm_b32 v197, v194, v192, s40
    v_perm_b32 v198, v174, v172, s40
    global_store_dwordx3 v179, v[196:198], s[50:51] offset:-3456
    v_perm_b32 v200, v190, v188, s41
    v_perm_b32 v201, v194, v192, s41
    v_perm_b32 v202, v174, v172, s41
    global_store_dwordx3 v179, v[200:202], s[50:51] offset:-1152
    v_perm_b32 v176, v191, v189, s40
    v_perm_b32 v177, v195, v193, s40
    v_perm_b32 v178, v175, v173, s40
    global_store_dwordx3 v179, v[176:178], s[50:51] offset:1152
    v_perm_b32 v188, v191, v189, s41
    v_perm_b32 v189, v195, v193, s41
    v_perm_b32 v190, v175, v173, s41
    global_store_dwordx3 v179, v[188:190], s[50:51] offset:3456
L_fd5:
    ds_read_b32 v204, v205 offset:1792
    s_waitcnt lgkmcnt(0)
    v_readfirstlane_b32 s33, v204
    s_cmp_lt_u32 s33, 6
    s_cbranch_scc1 L_wf8
L_wf8_e:
    ds_read_b32 v172, v3 offset:3584
    ds_read_b32 v173, v3 offset:18816
    ds_read_b32 v174, v3 offset:34048
    ds_read_b32 v175, v3 offset:49280
    ds_read_b32 v176, v211 offset:3584
    ds_read_b32 v177, v211 offset:34048
    s_waitcnt lgkmcnt(0)
    v_perm_b32 v172, v173, v172, s58
    v_perm_b32 v173, v175, v174, s58
    v_perm_b32 v174, v177, v176, s58
    global_store_dwordx3 v4, v[172:174], s[24:25]
    s_branch L_fin
L_pollf:
    ds_read_b32 v206, v210 offset:0
    s_waitcnt lgkmcnt(0)
    v_readfirstlane_b32 s33, v206
    s_cmp_lt_u32 s33, 4
    s_cbranch_scc0 L_pollf_e
    s_sub_u32 s53, s53, 1
    s_cbranch_scc0 L_pollf
    s_endpgm
L_wf1:
    ds_read_b32 v204, v205 offset:0
    s_waitcnt lgkmcnt(0)
    v_readfirstlane_b32 s33, v204
    s_cmp_lt_u32 s33, 6
    s_cbranch_scc0 L_wf1_e
    s_sub_u32 s53, s53, 1
    s_cbranch_scc0 L_wf1
    s_endpgm
L_fp1:
    ds_read_b32 v204, v205 offset:256
    s_waitcnt lgkmcnt(0)
    v_readfirstlane_b32 s33, v204
    s_cmp_lt_u32 s33, 6
    s_cbranch_scc0 L_fp1_e
    s_sub_u32 s53, s53, 1
    s_cbranch_scc0 L_fp1
    s_endpgm
L_uf:
    ds_read_b32 v204, v210 offset:4
    s_waitcnt lgkmcnt(0)
    v_readfirstlane_b32 s33, v204
    s_cmp_lt_u32 s33, 4
    s_cbranch_scc0 L_uf_e
    s_sub_u32 s53, s53, 1
    s_cbranch_scc0 L_uf
    s_endpgm
L_fp3:
    ds_read_b32 v204, v205 offset:768
    s_waitcnt lgkmcnt(0)
    v_readfirstlane_b32 s33, v204
    s_cmp_lt_u32 s33, 6
    s_cbranch_scc0 L_fp3_e
    s_sub_u32 s53, s53, 1
    s_cbranch_scc0 L_fp3
    s_endpgm
L_fp5:
    ds_read_b32 v204, v205 offset:1280
    s_waitcnt lgkmcnt(0)
    v_readfirstlane_b32 s33, v204
    s_cmp_lt_u32 s33, 6
    s_cbranch_scc0 L_fp5_e
    s_sub_u32 s53, s53, 1
    s_cbranch_scc0 L_fp5
    s_endpgm
L_wf8:
    ds_read_b32 v204, v205 offset:1792
    s_waitcnt lgkmcnt(0)
    v_readfirstlane_b32 s33, v204
    s_cmp_lt_u32 s33, 6
    s_cbranch_scc0 L_wf8_e
    s_sub_u32 s53, s53, 1
    s_cbranch_scc0 L_wf8
    s_endpgm
L_io0:
    s_waitcnt vmcnt(4)
    s_cmp_eq_u32 s4, 4
    s_cbranch_scc1 L_io1
    s_waitcnt vmcnt(0)
    global_load_dwordx2 v[172:173], v7, s[8:9] offset:0
    global_load_dwordx2 v[176:177], v7, s[8:9] offset:1152
    global_load_dwordx2 v[180:181], v7, s[8:9] offset:2304
    global_load_dwordx2 v[184:185], v7, s[8:9] offset:3456
    s_cmp_eq_u32 s4, 7
    s_cbranch_scc0 L_io1
    global_load_dword v188, v232, s[8:9]
    v_add_u32 v232, 589824, v232
    global_load_dword v189, v232, s[8:9]
L_io1:
    v_subrev_u32 v4, 4128768, v4
    v_cndmask_b32 v165, 0, 1, vcc
    s_waitcnt vmcnt(2)
    s_cmp_eq_u32 s4, 7
    s_cbranch_scc1 L_io2
    s_waitcnt vmcnt(0)
L_io2:
    v_add_u32 v7, 1179648, v7
    global_load_dwordx2 v[188:189], v7, s[8:9] offset:0
    global_load_dwordx2 v[192:193], v7, s[8:9] offset:1152
    global_load_dwordx2 v[196:197], v7, s[8:9] offset:2304
    global_load_dwordx2 v[200:201], v7, s[8:9] offset:3456
    v_perm_b32 v212, v176, v172, s40
    v_perm_b32 v213, v184, v180, s40
    ds_write_b64 v253, v[212:213] offset:0
    v_perm_b32 v214, v176, v172, s41
    v_perm_b32 v215, v184, v180, s41
    ds_write_b64 v253, v[214:215] offset:4608
    v_perm_b32 v216, v177, v173, s40
    v_perm_b32 v217, v185, v181, s40
    ds_write_b64 v253, v[216:217] offset:9216
    v_perm_b32 v218, v177, v173, s41
    v_perm_b32 v219, v185, v181, s41
    ds_write_b64 v253, v[218:219] offset:13824
    ds_add_u32 v208, v165 offset:2048
    v_mov_b32 v210, 157704
    s_mov_b32 s42, 0
    s_waitcnt vmcnt(0)
    v_perm_b32 v212, v192, v188, s40
    v_perm_b32 v213, v200, v196, s40
    ds_write_b64 v253, v[212:213] offset:2048
    v_perm_b32 v214, v192, v188, s41
    v_perm_b32 v215, v200, v196, s41
    ds_write_b64 v253, v[214:215] offset:6656
    v_perm_b32 v216, v193, v189, s40
    v_perm_b32 v217, v201, v197, s40
    ds_write_b64 v253, v[216:217] offset:11264
    v_perm_b32 v218, v193, v189, s41
    v_perm_b32 v219, v201, v197, s41
    ds_write_b64 v253, v[218:219] offset:15872
    ds_add_u32 v208, v165 offset:2052
L_iop:
    ds_read_b32 v8, v210
    s_waitcnt lgkmcnt(0)
    v_readfirstlane_b32 s33, v8
    s_cmp_ge_u32 s33, 4
    s_cbranch_scc1 L_iop_e
    s_sub_u32 s53, s53, 1
    s_cbranch_scc0 L_iop
    s_endpgm
L_iop_e:
    ds_read_b32 v8, v3 offset:0
    ds_read_b32 v9, v3 offset:15232
    ds_read_b32 v10, v3 offset:30464
    ds_read_b32 v11, v3 offset:45696
    v_add_u32 v210, 256, v210
    v_add_u32 v3, 512, v3
    s_waitcnt lgkmcnt(0)
    v_perm_b32 v12, v9, v8, s58
    v_perm_b32 v13, v11, v10, s58
    global_store_dwordx2 v4, v[12:13], s[24:25]
    s_add_u32 s24, s24, 589824
    s_addc_u32 s25, s25, 0
    s_add_u32 s42, s42, 1
    s_cmp_lt_u32 s42, 8
    s_cbranch_scc1 L_iop
L_fin:
L_end:
    s_endpgm
.section .rodata,"a"
.p2align 6
.amdhsa_kernel concat_heads__ssm_conv_s4d__ssm_conv_s4d__prompt_kernel
  .amdhsa_next_free_vgpr 256
  .amdhsa_next_free_sgpr 100
  .amdhsa_accum_offset 256
  .amdhsa_group_segment_fixed_size 0
  .amdhsa_kernarg_size 136
  .amdhsa_user_sgpr_count 2
  .amdhsa_user_sgpr_kernarg_segment_ptr 1
  .amdhsa_system_sgpr_workgroup_id_x 1
.end_amdhsa_kernel
```
